```python
import torch

def _softmax(x, axis=-1):
    return torch.softmax(x, dim=axis)
def _gelu(x):
    return torch.nn.functional.gelu(x, approximate="tanh")
def _silu(x):
    return torch.nn.functional.silu(x)
def _sigmoid(x):
    return torch.sigmoid(x)
def _layernorm(x, axis=-1, eps=1e-5):
    m = x.mean(dim=axis, keepdim=True)
    v = x.var(dim=axis, keepdim=True, unbiased=False)
    return (x - m) / torch.sqrt(v + eps)
def _scatter_add(tgt, idx, src, axis=0):
    return tgt.clone().index_add_(axis, idx, src)
def _segment_sum(src, seg, n):
    out = torch.zeros((n,) + src.shape[1:], dtype=src.dtype)
    return out.index_add_(0, seg, src)
def _pad(x, pw):
    flat = tuple(v for pair in reversed(pw) for v in pair)
    return torch.nn.functional.pad(x, flat)

kernel_name = 'recurrent_scan__spectral_fnet__geglu_ffn__prompt'

def setup_inputs():

    _w = (lambda a: (lambda t: t.to(torch.bfloat16) if t.is_floating_point() else t)(torch.as_tensor(a)))
    def _A_setup():
        B, S, D = 1, 2048, 512
        ns = torch.arange(S)[:, None] * torch.arange(S)[None, :]
        nd = torch.arange(D)[:, None] * torch.arange(D)[None, :]
        Ws_re = torch.cos(-2.0 * torch.pi * ns / S).to(float)
        Ws_im = torch.sin(-2.0 * torch.pi * ns / S).to(float)
        Wd_re = torch.cos(-2.0 * torch.pi * nd / D).to(float)
        Wd_im = torch.sin(-2.0 * torch.pi * nd / D).to(float)
        return {
            "x": _w((lambda *s: torch.randn(*s, dtype=torch.bfloat16) * 0.05)(B, S, D)),
            "dft_seq_re": _w(Ws_re),
            "dft_seq_im": _w(Ws_im),
            "dft_hid_re": _w(Wd_re),
            "dft_hid_im": _w(Wd_im),
        }
    _A_in = _A_setup()

    def _B_setup():
        B, S, D, F = 1, 2048, 512, 1792
        return {
            "x": _w((lambda *s: torch.randn(*s, dtype=torch.bfloat16) * 0.05)(B, S, D)),
            "w_gate": _w((lambda *s: torch.randn(*s, dtype=torch.bfloat16) * 0.05)(D, F)),
            "w_up": _w((lambda *s: torch.randn(*s, dtype=torch.bfloat16) * 0.05)(D, F)),
            "w_down": _w((lambda *s: torch.randn(*s, dtype=torch.bfloat16) * 0.05)(F, D)),
        }
    _B_in = _B_setup()

    return {
        "A_x": _A_in["x"],
        "A_dft_seq_re": _A_in["dft_seq_re"],
        "A_dft_seq_im": _A_in["dft_seq_im"],
        "A_dft_hid_re": _A_in["dft_hid_re"],
        "A_dft_hid_im": _A_in["dft_hid_im"],
        "B_x": _B_in["x"],
        "B_w_gate": _B_in["w_gate"],
        "B_w_up": _B_in["w_up"],
        "B_w_down": _B_in["w_down"],
    }

def reference(A_x, A_dft_seq_re, A_dft_seq_im, A_dft_hid_re, A_dft_hid_im, B_x, B_w_gate, B_w_up, B_w_down):
    def _A_ref(x, dft_seq_re, dft_seq_im, dft_hid_re, dft_hid_im):
        a = torch.einsum("bsd,ed->bse", x, dft_hid_re)
        b = torch.einsum("bsd,ed->bse", x, dft_hid_im)
        y = torch.einsum("ts,bse->bte", dft_seq_re, a) - torch.einsum("ts,bse->bte", dft_seq_im, b)
        return y

    def _B_ref(x, w_gate, w_up, w_down):
        return (_gelu(x @ w_gate) * (x @ w_up)) @ w_down

    x = A_x
    xn = _layernorm(x, axis=-1)
    s = _A_ref(xn, A_dft_seq_re, A_dft_seq_im, A_dft_hid_re, A_dft_hid_im)
    g = _silu(_B_ref(xn, B_w_gate, B_w_up, B_w_down))
    return x + s * g
```

```asm
; @launch grid=(256,1,1) block=(512,1,1) lds=163840
.amdgcn_target "amdgcn-amd-amdhsa--gfx950"
.text
.globl recurrent_scan__spectral_fnet__geglu_ffn__prompt_kernel
.p2align 8
.type recurrent_scan__spectral_fnet__geglu_ffn__prompt_kernel,@function
recurrent_scan__spectral_fnet__geglu_ffn__prompt_kernel:
    s_cmp_ge_u32 s2, 256
    s_cbranch_scc1 L_end
    s_load_dwordx16 s[32:47], s[0:1], 0
    s_load_dwordx2 s[28:29], s[0:1], 64
    s_load_dwordx2 s[26:27], s[0:1], 72
    s_load_dwordx2 s[24:25], s[0:1], 80
    s_load_dwordx2 s[30:31], s[0:1], 88
    s_memrealtime s[78:79]
    v_lshrrev_b32 v2, 6, v0
    v_and_b32 v1, 63, v0
    v_readfirstlane_b32 s50, v2
    s_getpc_b64 s[4:5]
L_pc:
    s_cmp_lg_u32 s50, 2
    s_cbranch_scc1 L_nct
    s_and_b32 s6, s2, 0xf8
    v_and_b32 v2, 7, v0
    v_add_u32 v2, s6, v2
    v_lshlrev_b32 v2, 7, v2
    v_min_u32 v2, L_end-L_pc, v2
    global_load_dword v189, v2, s[4:5]
L_nct:
    s_and_b32 s64, s2, 3
    s_lshl_b32 s64, s64, 2
    s_bfe_u32 s48, s2, 0x20003
    s_add_u32 s48, s48, s64
    s_bfe_u32 s64, s2, 0x10002
    s_lshr_b32 s65, s2, 5
    s_mul_i32 s49, s64, 7
    s_add_u32 s49, s49, s65
    s_sub_u32 s49, s49, 1
    s_add_u32 s64, s64, 14
    s_cmp_eq_u32 s65, 0
    s_cselect_b32 s49, s64, s49
    s_cselect_b32 s67, 1, 0
    s_cselect_b32 s60, 2, 7
    s_lshl_b32 s60, s60, 9
    s_lshl_b32 s52, s60, 9
    s_lshr_b32 s62, s50, 2
    s_and_b32 s63, s50, 3
    s_lshl_b32 s57, s63, 10
    v_bfe_u32 v2, v0, 3, 5
    v_bfe_u32 v3, v2, 1, 3
    v_and_b32 v4, 7, v1
    v_xor_b32 v3, v3, v4
    v_lshlrev_b32 v3, 4, v3
    s_lshl_b32 s59, s49, 8
    s_cmp_eq_u32 s67, 1
    s_cbranch_scc1 L_rows_dft
    v_mul_lo_u32 v5, v2, s60
    v_bfe_u32 v6, v1, 4, 1
    v_lshlrev_b32 v6, 2, v6
    v_xor_b32 v6, v6, v4
    v_lshlrev_b32 v165, 4, v6
    v_add3_u32 v164, v5, v165, s59
    v_lshlrev_b32 v2, 4, v2
    v_add_u32 v2, s48, v2
    s_mov_b32 s64, 524288
    s_mov_b32 s65, 1048576
    s_branch L_rows_done
L_rows_dft:
    s_sub_u32 s59, s59, 3072
    v_lshrrev_b32 v5, 4, v0
    v_and_b32 v6, 3, v5
    v_lshlrev_b32 v6, 2, v6
    v_and_b32 v4, 15, v1
    v_xor_b32 v6, v6, v4
    v_lshlrev_b32 v6, 4, v6
    v_lshlrev_b32 v5, 10, v5
    v_add3_u32 v164, v5, v6, s59
    v_add_u32 v165, 16384, v164
    v_and_b32 v4, 1, v2
    v_lshlrev_b32 v4, 1, v4
    v_and_or_b32 v4, v2, 4, v4
    v_bfe_u32 v5, v2, 1, 1
    v_lshl_add_u32 v4, v5, 7, v4
    v_bfe_u32 v5, v2, 3, 2
    v_lshl_add_u32 v4, v5, 8, v4
    s_lshr_b32 s65, s48, 1
    s_lshl_b32 s65, s65, 4
    s_and_b32 s64, s48, 1
    s_add_u32 s65, s65, s64
    v_add_u32 v2, s65, v4
    s_mov_b32 s64, 1048576
    s_mov_b32 s65, 8192
L_rows_done:
    v_lshl_add_u32 v160, v2, 10, v3
    v_add_u32 v161, s64, v160
    v_add_u32 v162, s65, v160
    v_add_u32 v163, s65, v161
    s_waitcnt lgkmcnt(0)
    s_mov_b32 s4, s32
    s_mov_b32 s5, s33
    s_mov_b32 s6, 2097152
    s_mov_b32 s7, 0x20000
    s_cmp_eq_u32 s67, 1
    s_cselect_b32 s12, s38, s44
    s_cselect_b32 s13, s39, s45
    s_cselect_b32 s16, s40, s46
    s_cselect_b32 s17, s41, s47
    s_mov_b32 s14, s52
    s_mov_b32 s15, 0x20000
    s_mov_b32 s18, s52
    s_mov_b32 s19, 0x20000
    s_mov_b32 vcc_lo, s62
    s_mov_b32 vcc_hi, 0
    s_cmp_ge_u32 s2, 8
    s_cbranch_scc1 L_nononce
    s_cmp_lg_u32 s50, 7
    s_cbranch_scc1 L_nononce
    s_or_b32 s78, s78, 1
    v_mov_b32 v2, s78
    v_mov_b32 v3, s79
    v_mov_b32 v4, 0
    v_mov_b32 v5, 0
    s_mov_b64 exec, 1
    global_atomic_cmpswap_x2 v4, v[2:5], s[24:25] sc1
    s_mov_b64 exec, -1
    s_nop 0
L_nononce:
    s_cmp_eq_u32 s67, 1
    s_cbranch_scc1 L_dft
    s_mov_b32 s3, 3
    s_cbranch_vccnz L_g1
    s_mov_b32 s40, s28
    s_mov_b32 s41, s29
    s_mov_b32 s42, 1835008
    s_mov_b32 s43, 0x20000
    s_and_b32 s64, s48, 1
    s_lshl_b32 s64, s64, 2
    s_lshl_b32 s65, s49, 3
    s_add_u32 s64, s64, s65
    s_and_b32 s65, s50, 3
    s_add_u32 s64, s64, s65
    s_lshl_b32 s64, s64, 14
    s_lshr_b32 s65, s48, 1
    s_lshl_b32 s65, s65, 7
    s_add_u32 s64, s64, s65
    v_lshrrev_b32 v4, 3, v1
    v_lshl_add_u32 v4, v4, 10, v165
    s_add_u32 m0, s57, 155648
    s_add_u32 s65, s64, 8192
    buffer_load_dwordx4 v4, s[40:43], s64 offen lds
    s_add_u32 m0, s57, 159744
    s_nop 0
    buffer_load_dwordx4 v4, s[40:43], s65 offen lds
    s_bfe_u32 s71, s50, 0x10001
    s_and_b32 s63, s50, 1
    v_lshrrev_b32 v2, 5, v1
    v_and_b32 v3, 31, v1
    v_bfe_u32 v5, v1, 3, 1
    v_xor_b32 v5, s63, v5
    v_lshlrev_b32 v5, 6, v5
    v_lshl_add_u32 v5, v2, 10, v5
    v_bfe_u32 v4, v1, 2, 2
    v_lshl_add_u32 v5, v4, 7, v5
    v_and_b32 v4, 3, v1
    v_lshl_add_u32 v5, v4, 3, v5
    v_bfe_u32 v4, v1, 4, 1
    v_lshl_add_u32 v5, v4, 5, v5
    s_lshl_b32 s65, s71, 12
    v_add_u32 v140, s65, v5
    v_xor_b32 v141, 4096, v140
    v_and_b32 v5, 15, v1
    v_lshlrev_b32 v4, 2, v4
    v_sub_u32 v5, v5, v4
    v_cmp_eq_u32 s[78:79], 0, v5
    v_cmp_eq_u32 s[76:77], 8, v5
    v_mov_b32 v5, 0x3f803f80
    v_bfe_u32 v4, v1, 1, 3
    v_cndmask_b32 v148, 0, v5, s[78:79]
    v_cndmask_b32 v152, 0, v5, s[76:77]
    v_cndmask_b32 v149, 0, v5, s[78:79]
    v_cndmask_b32 v153, 0, v5, s[76:77]
    v_cndmask_b32 v150, 0, v5, s[78:79]
    v_cndmask_b32 v154, 0, v5, s[76:77]
    v_cndmask_b32 v151, 0, v5, s[78:79]
    v_cndmask_b32 v155, 0, v5, s[76:77]
    v_xor_b32 v4, v4, v2
    v_lshlrev_b32 v4, 4, v4
    v_lshl_add_u32 v4, v3, 7, v4
    s_mul_i32 s64, s71, 8256
    v_xor_b32 v4, s64, v4
    v_xor_b32 v128, 0, v4
    v_xor_b32 v129, 32, v4
    v_xor_b32 v130, 64, v4
    v_xor_b32 v131, 96, v4
    v_add_u32 v132, 49152, v128
    v_add_u32 v133, 49152, v129
    v_add_u32 v134, 49152, v130
    v_add_u32 v135, 49152, v131
    v_add_u32 v142, 49152, v140
    v_add_u32 v143, 49152, v141
    v_add_u32 v136, 98304, v128
    v_add_u32 v137, 98304, v129
    v_add_u32 v138, 98304, v130
    v_add_u32 v139, 98304, v131
    v_add_u32 v144, 98304, v140
    v_add_u32 v145, 98304, v141
    v_mov_b32 v166, 0
    v_mov_b32 v167, 0
    v_mov_b32 v4, 147456
    ds_write_b64 v4, v[166:167] offset:0
    ds_write_b64 v4, v[166:167] offset:8
    s_mul_i32 s55, s48, 28
    s_mul_i32 s64, s62, 14
    s_add_u32 s55, s55, s64
    s_add_u32 s55, s55, s49
    s_lshl_b32 s55, s55, 7
    s_add_u32 s55, s55, 9572352
    s_lshl_b32 s64, s48, 11
    s_lshl_b32 s65, s71, 10
    s_add_u32 s64, s64, s65
    s_add_u32 s64, s64, 9510912
    v_and_b32 v4, 7, v1
    v_lshlrev_b32 v4, 3, v4
    v_lshrrev_b32 v5, 3, v1
    v_lshl_add_u32 v4, v5, 7, v4
    v_add_u32 v171, s64, v4
    v_lshlrev_b32 v4, 2, v0
    v_add_u32 v168, 151552, v4
    s_and_b32 s64, s50, 5
    s_lshl_b32 s64, s64, 8
    s_add_u32 s64, s64, 151552
    v_lshlrev_b32 v4, 2, v3
    v_lshl_add_u32 v4, v2, 9, v4
    v_add_u32 v169, s64, v4
    s_lshl_b32 s64, s48, 2
    s_lshl_b32 s65, s71, 1
    s_add_u32 s64, s64, s65
    s_mul_i32 s74, s64, 114688
    s_lshl_b32 s64, s49, 13
    s_lshl_b32 s65, s62, 12
    s_add_u32 s64, s64, s65
    s_lshl_b32 s65, s63, 11
    s_add_u32 s64, s64, s65
    s_add_u32 s74, s74, s64
    s_add_u32 s75, s74, 114688
    v_mov_b32 v183, 0
    v_mov_b32 v185, 0
    v_mov_b32 v186, 0
    v_mov_b32 v187, 0
    s_mov_b32 s20, s30
    s_mov_b32 s21, s31
    s_mov_b32 s22, 12582912
    s_mov_b32 s23, 0x20000
    s_mov_b32 s66, 0xffff0000
    s_lshl_b32 s72, s48, 4
    s_add_u32 s72, s72, s49
    s_lshl_b32 s72, s72, 7
    s_add_u32 s72, s72, 9510912
    s_bfe_u32 s69, s2, 0x30003
    s_and_b32 s68, s2, 7
    s_lshl_b32 s68, s68, 2
    s_lshr_b32 s65, s2, 6
    s_add_u32 s68, s68, s65
    s_lshr_b32 s70, s68, 1
    s_mul_i32 s64, s69, 7
    s_add_u32 s64, s64, s50
    s_lshl_b32 s51, s64, 15
    s_add_u32 s51, s51, 10485760
    s_lshl_b32 s64, s64, 9
    s_add_u32 s64, s64, 9629696
    v_and_b32 v4, 3, v1
    v_lshlrev_b32 v4, 7, v4
    v_add_u32 v174, s64, v4
    s_mul_i32 s64, s70, 3584
    s_lshl_b32 s65, s50, 9
    s_add_u32 s64, s64, s65
    s_add_u32 s64, s64, 9572352
    s_add_u32 s36, s30, s64
    s_addc_u32 s37, s31, 0
    v_lshlrev_b32 v6, 4, v1
    v_lshrrev_b32 v4, 5, v1
    v_bfe_u32 v5, v1, 2, 2
    v_lshl_add_u32 v5, v4, 2, v5
    v_lshlrev_b32 v5, 7, v5
    v_bfe_u32 v4, v1, 3, 1
    v_lshl_add_u32 v5, v4, 6, v5
    v_bfe_u32 v4, v1, 4, 1
    v_lshl_add_u32 v5, v4, 5, v5
    v_and_b32 v4, 3, v1
    v_lshl_add_u32 v5, v4, 3, v5
    s_add_u32 s64, s57, 155648
    v_add_u32 v5, s64, v5
    v_xor_b32 v4, 64, v5
    s_waitcnt vmcnt(0)
    ds_read_b64_tr_b16 v[192:193], v5 offset:0
    ds_read_b64_tr_b16 v[194:195], v5 offset:4096
    ds_read_b64_tr_b16 v[196:197], v4 offset:0
    ds_read_b64_tr_b16 v[198:199], v4 offset:4096
    s_mul_i32 s58, s48, 14
    s_add_u32 s58, s58, s49
    s_lshl_b32 s64, s58, 13
    s_lshl_b32 s65, s57, 1
    s_add_u32 s64, s64, s65
    s_add_u32 s64, s64, 10485760
    s_lshl_b32 s58, s58, 7
    s_add_u32 s58, s58, 9629696
    s_waitcnt lgkmcnt(0)
    buffer_store_dwordx4 v[192:195], v6, s[20:23], s64 offen offset:0 sc1
    buffer_store_dwordx4 v[196:199], v6, s[20:23], s64 offen offset:1024 sc1
    s_setprio 2
    s_waitcnt lgkmcnt(0)
    s_barrier
    ds_read_b128 v[80:83], v128 offset:16384
    ds_read_b64_tr_b16 v[88:89], v140 offset:0
    ds_read_b64_tr_b16 v[90:91], v140 offset:512
    ds_read_b64_tr_b16 v[92:93], v140 offset:8192
    ds_read_b64_tr_b16 v[94:95], v140 offset:8704
    ds_read_b128 v[84:87], v128 offset:20480
    ds_read_b128 v[96:99], v129 offset:16384
    ds_read_b64_tr_b16 v[104:105], v140 offset:2048
    ds_read_b64_tr_b16 v[106:107], v140 offset:2560
    ds_read_b64_tr_b16 v[108:109], v140 offset:10240
    ds_read_b64_tr_b16 v[110:111], v140 offset:10752
    ds_read_b128 v[100:103], v129 offset:20480
    s_waitcnt lgkmcnt(6)
    v_mfma_f32_32x32x16_bf16 v[16:31], v[88:91], v[80:83], 0
    ds_read_b128 v[112:115], v130 offset:16384
    ds_read_b64_tr_b16 v[120:121], v141 offset:0
    v_mfma_f32_32x32x16_bf16 v[32:47], v[92:95], v[80:83], 0
    ds_read_b64_tr_b16 v[122:123], v141 offset:512
    ds_read_b64_tr_b16 v[124:125], v141 offset:8192
    v_mfma_f32_32x32x16_bf16 v[48:63], v[88:91], v[84:87], 0
    ds_read_b64_tr_b16 v[126:127], v141 offset:8704
    ds_read_b128 v[116:119], v130 offset:20480
    v_mfma_f32_16x16x32_bf16 v[156:159], v[148:151], v[88:91], 0
    v_mfma_f32_32x32x16_bf16 v[64:79], v[92:95], v[84:87], 0
    v_mfma_f32_16x16x32_bf16 v[156:159], v[152:155], v[92:95], v[156:159]
    s_waitcnt lgkmcnt(6)
    v_mfma_f32_32x32x16_bf16 v[16:31], v[104:107], v[96:99], v[16:31]
    ds_read_b128 v[80:83], v131 offset:16384
    ds_read_b64_tr_b16 v[88:89], v141 offset:2048
    v_mfma_f32_32x32x16_bf16 v[32:47], v[108:111], v[96:99], v[32:47]
    ds_read_b64_tr_b16 v[90:91], v141 offset:2560
    ds_read_b64_tr_b16 v[92:93], v141 offset:10240
    v_mfma_f32_32x32x16_bf16 v[48:63], v[104:107], v[100:103], v[48:63]
    ds_read_b64_tr_b16 v[94:95], v141 offset:10752
    ds_read_b128 v[84:87], v131 offset:20480
    v_mfma_f32_16x16x32_bf16 v[156:159], v[148:151], v[104:107], v[156:159]
    v_mfma_f32_32x32x16_bf16 v[64:79], v[108:111], v[100:103], v[64:79]
    v_mfma_f32_16x16x32_bf16 v[156:159], v[152:155], v[108:111], v[156:159]
    s_waitcnt lgkmcnt(6)
    v_mfma_f32_32x32x16_bf16 v[16:31], v[120:123], v[112:115], v[16:31]
    s_waitcnt lgkmcnt(0)
    s_barrier
    ds_read_b128 v[96:99], v132 offset:0
    ds_read_b64_tr_b16 v[104:105], v140 offset:32768
    v_mfma_f32_32x32x16_bf16 v[32:47], v[124:127], v[112:115], v[32:47]
    ds_read_b64_tr_b16 v[106:107], v140 offset:33280
    ds_read_b64_tr_b16 v[108:109], v140 offset:40960
    v_mfma_f32_32x32x16_bf16 v[48:63], v[120:123], v[116:119], v[48:63]
    ds_read_b64_tr_b16 v[110:111], v140 offset:41472
    ds_read_b128 v[100:103], v132 offset:4096
    v_mfma_f32_32x32x16_bf16 v[64:79], v[124:127], v[116:119], v[64:79]
    v_mfma_f32_32x32x16_bf16 v[16:31], v[88:91], v[80:83], v[16:31]
    ds_read_b128 v[112:115], v133 offset:0
    ds_read_b64_tr_b16 v[120:121], v140 offset:34816
    v_mfma_f32_32x32x16_bf16 v[32:47], v[92:95], v[80:83], v[32:47]
    ds_read_b64_tr_b16 v[122:123], v140 offset:35328
    ds_read_b64_tr_b16 v[124:125], v140 offset:43008
    v_mfma_f32_32x32x16_bf16 v[48:63], v[88:91], v[84:87], v[48:63]
    ds_read_b64_tr_b16 v[126:127], v140 offset:43520
    ds_read_b128 v[116:119], v133 offset:4096
    v_mfma_f32_32x32x16_bf16 v[64:79], v[92:95], v[84:87], v[64:79]
    s_waitcnt lgkmcnt(6)
    v_mfma_f32_32x32x16_bf16 v[16:31], v[104:107], v[96:99], v[16:31]
    ds_read_b128 v[80:83], v134 offset:0
    ds_read_b64_tr_b16 v[88:89], v141 offset:32768
    v_mfma_f32_32x32x16_bf16 v[32:47], v[108:111], v[96:99], v[32:47]
    ds_read_b64_tr_b16 v[90:91], v141 offset:33280
    ds_read_b64_tr_b16 v[92:93], v141 offset:40960
    v_mfma_f32_32x32x16_bf16 v[48:63], v[104:107], v[100:103], v[48:63]
    ds_read_b64_tr_b16 v[94:95], v141 offset:41472
    ds_read_b128 v[84:87], v134 offset:4096
    v_mfma_f32_16x16x32_bf16 v[156:159], v[148:151], v[104:107], v[156:159]
    v_mfma_f32_32x32x16_bf16 v[64:79], v[108:111], v[100:103], v[64:79]
    global_load_dwordx2 v[14:15], v166, s[24:25] sc1
    v_mfma_f32_16x16x32_bf16 v[156:159], v[152:155], v[108:111], v[156:159]
    s_waitcnt lgkmcnt(6)
    v_mfma_f32_32x32x16_bf16 v[16:31], v[120:123], v[112:115], v[16:31]
    ds_read_b128 v[96:99], v135 offset:0
    ds_read_b64_tr_b16 v[104:105], v141 offset:34816
    v_mfma_f32_32x32x16_bf16 v[32:47], v[124:127], v[112:115], v[32:47]
    ds_read_b64_tr_b16 v[106:107], v141 offset:35328
    ds_read_b64_tr_b16 v[108:109], v141 offset:43008
    v_mfma_f32_32x32x16_bf16 v[48:63], v[120:123], v[116:119], v[48:63]
    ds_read_b64_tr_b16 v[110:111], v141 offset:43520
    ds_read_b128 v[100:103], v135 offset:4096
    v_mfma_f32_16x16x32_bf16 v[156:159], v[148:151], v[120:123], v[156:159]
    v_mfma_f32_32x32x16_bf16 v[64:79], v[124:127], v[116:119], v[64:79]
    v_mfma_f32_16x16x32_bf16 v[156:159], v[152:155], v[124:127], v[156:159]
    s_waitcnt lgkmcnt(6)
    v_mfma_f32_32x32x16_bf16 v[16:31], v[88:91], v[80:83], v[16:31]
    s_waitcnt lgkmcnt(0)
    s_barrier
    ds_read_b128 v[112:115], v132 offset:32768
    ds_read_b64_tr_b16 v[120:121], v142 offset:16384
    v_mfma_f32_32x32x16_bf16 v[32:47], v[92:95], v[80:83], v[32:47]
    ds_read_b64_tr_b16 v[122:123], v142 offset:16896
    ds_read_b64_tr_b16 v[124:125], v142 offset:24576
    v_mfma_f32_32x32x16_bf16 v[48:63], v[88:91], v[84:87], v[48:63]
    ds_read_b64_tr_b16 v[126:127], v142 offset:25088
    ds_read_b128 v[116:119], v132 offset:36864
    v_mfma_f32_32x32x16_bf16 v[64:79], v[92:95], v[84:87], v[64:79]
    v_mfma_f32_32x32x16_bf16 v[16:31], v[104:107], v[96:99], v[16:31]
    ds_read_b128 v[80:83], v133 offset:32768
    ds_read_b64_tr_b16 v[88:89], v142 offset:18432
    v_mfma_f32_32x32x16_bf16 v[32:47], v[108:111], v[96:99], v[32:47]
    ds_read_b64_tr_b16 v[90:91], v142 offset:18944
    ds_read_b64_tr_b16 v[92:93], v142 offset:26624
    v_mfma_f32_32x32x16_bf16 v[48:63], v[104:107], v[100:103], v[48:63]
    ds_read_b64_tr_b16 v[94:95], v142 offset:27136
    ds_read_b128 v[84:87], v133 offset:36864
    v_mfma_f32_32x32x16_bf16 v[64:79], v[108:111], v[100:103], v[64:79]
    s_waitcnt lgkmcnt(6)
    v_mfma_f32_32x32x16_bf16 v[16:31], v[120:123], v[112:115], v[16:31]
    ds_read_b128 v[96:99], v134 offset:32768
    ds_read_b64_tr_b16 v[104:105], v143 offset:16384
    v_mfma_f32_32x32x16_bf16 v[32:47], v[124:127], v[112:115], v[32:47]
    ds_read_b64_tr_b16 v[106:107], v143 offset:16896
    ds_read_b64_tr_b16 v[108:109], v143 offset:24576
    v_mfma_f32_32x32x16_bf16 v[48:63], v[120:123], v[116:119], v[48:63]
    ds_read_b64_tr_b16 v[110:111], v143 offset:25088
    ds_read_b128 v[100:103], v134 offset:36864
    v_mfma_f32_16x16x32_bf16 v[156:159], v[148:151], v[120:123], v[156:159]
    v_mfma_f32_32x32x16_bf16 v[64:79], v[124:127], v[116:119], v[64:79]
    v_mfma_f32_16x16x32_bf16 v[156:159], v[152:155], v[124:127], v[156:159]
    s_waitcnt lgkmcnt(6)
    v_mfma_f32_32x32x16_bf16 v[16:31], v[88:91], v[80:83], v[16:31]
    ds_read_b128 v[112:115], v135 offset:32768
    ds_read_b64_tr_b16 v[120:121], v143 offset:18432
    v_mfma_f32_32x32x16_bf16 v[32:47], v[92:95], v[80:83], v[32:47]
    ds_read_b64_tr_b16 v[122:123], v143 offset:18944
    ds_read_b64_tr_b16 v[124:125], v143 offset:26624
    v_mfma_f32_32x32x16_bf16 v[48:63], v[88:91], v[84:87], v[48:63]
    ds_read_b64_tr_b16 v[126:127], v143 offset:27136
    ds_read_b128 v[116:119], v135 offset:36864
    v_mfma_f32_16x16x32_bf16 v[156:159], v[148:151], v[88:91], v[156:159]
    v_mfma_f32_32x32x16_bf16 v[64:79], v[92:95], v[84:87], v[64:79]
    v_mfma_f32_16x16x32_bf16 v[156:159], v[152:155], v[92:95], v[156:159]
    s_waitcnt lgkmcnt(6)
    v_mfma_f32_32x32x16_bf16 v[16:31], v[104:107], v[96:99], v[16:31]
    s_waitcnt lgkmcnt(0)
    s_barrier
    ds_read_b128 v[80:83], v136 offset:16384
    ds_read_b64_tr_b16 v[88:89], v144 offset:0
    v_mfma_f32_32x32x16_bf16 v[32:47], v[108:111], v[96:99], v[32:47]
    ds_read_b64_tr_b16 v[90:91], v144 offset:512
    ds_read_b64_tr_b16 v[92:93], v144 offset:8192
    v_mfma_f32_32x32x16_bf16 v[48:63], v[104:107], v[100:103], v[48:63]
    ds_read_b64_tr_b16 v[94:95], v144 offset:8704
    ds_read_b128 v[84:87], v136 offset:20480
    v_mfma_f32_32x32x16_bf16 v[64:79], v[108:111], v[100:103], v[64:79]
    v_mfma_f32_32x32x16_bf16 v[16:31], v[120:123], v[112:115], v[16:31]
    ds_read_b128 v[96:99], v137 offset:16384
    ds_read_b64_tr_b16 v[104:105], v144 offset:2048
    v_mfma_f32_32x32x16_bf16 v[32:47], v[124:127], v[112:115], v[32:47]
    ds_read_b64_tr_b16 v[106:107], v144 offset:2560
    ds_read_b64_tr_b16 v[108:109], v144 offset:10240
    v_mfma_f32_32x32x16_bf16 v[48:63], v[120:123], v[116:119], v[48:63]
    ds_read_b64_tr_b16 v[110:111], v144 offset:10752
    ds_read_b128 v[100:103], v137 offset:20480
    v_mfma_f32_32x32x16_bf16 v[64:79], v[124:127], v[116:119], v[64:79]
    s_waitcnt lgkmcnt(6)
    v_mfma_f32_32x32x16_bf16 v[16:31], v[88:91], v[80:83], v[16:31]
    ds_read_b128 v[112:115], v138 offset:16384
    ds_read_b64_tr_b16 v[120:121], v145 offset:0
    v_mfma_f32_32x32x16_bf16 v[32:47], v[92:95], v[80:83], v[32:47]
    ds_read_b64_tr_b16 v[122:123], v145 offset:512
    ds_read_b64_tr_b16 v[124:125], v145 offset:8192
    v_mfma_f32_32x32x16_bf16 v[48:63], v[88:91], v[84:87], v[48:63]
    ds_read_b64_tr_b16 v[126:127], v145 offset:8704
    ds_read_b128 v[116:119], v138 offset:20480
    v_mfma_f32_16x16x32_bf16 v[156:159], v[148:151], v[88:91], v[156:159]
    v_mfma_f32_32x32x16_bf16 v[64:79], v[92:95], v[84:87], v[64:79]
    v_mfma_f32_16x16x32_bf16 v[156:159], v[152:155], v[92:95], v[156:159]
    s_waitcnt lgkmcnt(6)
    v_mfma_f32_32x32x16_bf16 v[16:31], v[104:107], v[96:99], v[16:31]
    ds_read_b128 v[80:83], v139 offset:16384
    ds_read_b64_tr_b16 v[88:89], v145 offset:2048
    v_mfma_f32_32x32x16_bf16 v[32:47], v[108:111], v[96:99], v[32:47]
    ds_read_b64_tr_b16 v[90:91], v145 offset:2560
    ds_read_b64_tr_b16 v[92:93], v145 offset:10240
    v_mfma_f32_32x32x16_bf16 v[48:63], v[104:107], v[100:103], v[48:63]
    ds_read_b64_tr_b16 v[94:95], v145 offset:10752
    ds_read_b128 v[84:87], v139 offset:20480
    v_mfma_f32_16x16x32_bf16 v[156:159], v[148:151], v[104:107], v[156:159]
    v_mfma_f32_32x32x16_bf16 v[64:79], v[108:111], v[100:103], v[64:79]
    s_waitcnt vmcnt(0)
    v_readfirstlane_b32 s61, v14
    s_cmp_eq_u32 s61, 0
    s_cbranch_scc1 L_ns25
L_nb24:
    v_readfirstlane_b32 s34, v14
    v_readfirstlane_b32 s35, v15
    v_mov_b32 v12, 147464
    v_mov_b32 v13, 1
    s_mov_b64 exec, 1
    ds_add_rtn_u32 v13, v12, v13
    s_waitcnt lgkmcnt(0)
    v_readfirstlane_b32 s73, v13
    s_mov_b64 exec, -1
    s_cmp_lg_u32 s73, s3
    s_cbranch_scc1 L_ar27
    s_mov_b64 exec, 1
    buffer_store_dwordx2 v[14:15], v166, s[20:23], s58 offen sc1
    s_mov_b64 exec, -1
L_ar27:
    v_mfma_f32_16x16x32_bf16 v[156:159], v[152:155], v[108:111], v[156:159]
    s_waitcnt lgkmcnt(6)
    v_mfma_f32_32x32x16_bf16 v[16:31], v[120:123], v[112:115], v[16:31]
    s_waitcnt lgkmcnt(0)
    s_barrier
    ds_read_b128 v[96:99], v128 offset:0
    ds_read_b64_tr_b16 v[104:105], v144 offset:32768
    v_mfma_f32_32x32x16_bf16 v[32:47], v[124:127], v[112:115], v[32:47]
    ds_read_b64_tr_b16 v[106:107], v144 offset:33280
    ds_read_b64_tr_b16 v[108:109], v144 offset:40960
    v_mfma_f32_32x32x16_bf16 v[48:63], v[120:123], v[116:119], v[48:63]
    ds_read_b64_tr_b16 v[110:111], v144 offset:41472
    ds_read_b128 v[100:103], v128 offset:4096
    v_mfma_f32_32x32x16_bf16 v[64:79], v[124:127], v[116:119], v[64:79]
    v_mfma_f32_32x32x16_bf16 v[16:31], v[88:91], v[80:83], v[16:31]
    ds_read_b128 v[112:115], v129 offset:0
    ds_read_b64_tr_b16 v[120:121], v144 offset:34816
    v_mfma_f32_32x32x16_bf16 v[32:47], v[92:95], v[80:83], v[32:47]
    ds_read_b64_tr_b16 v[122:123], v144 offset:35328
    ds_read_b64_tr_b16 v[124:125], v144 offset:43008
    v_mfma_f32_32x32x16_bf16 v[48:63], v[88:91], v[84:87], v[48:63]
    ds_read_b64_tr_b16 v[126:127], v144 offset:43520
    ds_read_b128 v[116:119], v129 offset:4096
    v_mfma_f32_32x32x16_bf16 v[64:79], v[92:95], v[84:87], v[64:79]
    s_waitcnt lgkmcnt(6)
    v_mfma_f32_32x32x16_bf16 v[16:31], v[104:107], v[96:99], v[16:31]
    ds_read_b128 v[80:83], v130 offset:0
    ds_read_b64_tr_b16 v[88:89], v145 offset:32768
    v_mfma_f32_32x32x16_bf16 v[32:47], v[108:111], v[96:99], v[32:47]
    ds_read_b64_tr_b16 v[90:91], v145 offset:33280
    ds_read_b64_tr_b16 v[92:93], v145 offset:40960
    v_mfma_f32_32x32x16_bf16 v[48:63], v[104:107], v[100:103], v[48:63]
    ds_read_b64_tr_b16 v[94:95], v145 offset:41472
    ds_read_b128 v[84:87], v130 offset:4096
    v_mfma_f32_16x16x32_bf16 v[156:159], v[148:151], v[104:107], v[156:159]
    v_mfma_f32_32x32x16_bf16 v[64:79], v[108:111], v[100:103], v[64:79]
    v_mfma_f32_16x16x32_bf16 v[156:159], v[152:155], v[108:111], v[156:159]
    s_waitcnt lgkmcnt(6)
    v_mfma_f32_32x32x16_bf16 v[16:31], v[120:123], v[112:115], v[16:31]
    ds_read_b128 v[96:99], v131 offset:0
    ds_read_b64_tr_b16 v[104:105], v145 offset:34816
    v_mfma_f32_32x32x16_bf16 v[32:47], v[124:127], v[112:115], v[32:47]
    ds_read_b64_tr_b16 v[106:107], v145 offset:35328
    ds_read_b64_tr_b16 v[108:109], v145 offset:43008
    v_mfma_f32_32x32x16_bf16 v[48:63], v[120:123], v[116:119], v[48:63]
    ds_read_b64_tr_b16 v[110:111], v145 offset:43520
    ds_read_b128 v[100:103], v131 offset:4096
    v_mfma_f32_16x16x32_bf16 v[156:159], v[148:151], v[120:123], v[156:159]
    v_mfma_f32_32x32x16_bf16 v[64:79], v[124:127], v[116:119], v[64:79]
    v_mfma_f32_16x16x32_bf16 v[156:159], v[152:155], v[124:127], v[156:159]
    s_waitcnt lgkmcnt(6)
    v_mfma_f32_32x32x16_bf16 v[16:31], v[88:91], v[80:83], v[16:31]
    s_waitcnt lgkmcnt(0)
    s_barrier
    ds_read_b128 v[112:115], v128 offset:32768
    ds_read_b64_tr_b16 v[120:121], v140 offset:16384
    v_mfma_f32_32x32x16_bf16 v[32:47], v[92:95], v[80:83], v[32:47]
    ds_read_b64_tr_b16 v[122:123], v140 offset:16896
    ds_read_b64_tr_b16 v[124:125], v140 offset:24576
    v_mfma_f32_32x32x16_bf16 v[48:63], v[88:91], v[84:87], v[48:63]
    ds_read_b64_tr_b16 v[126:127], v140 offset:25088
    ds_read_b128 v[116:119], v128 offset:36864
    v_mfma_f32_32x32x16_bf16 v[64:79], v[92:95], v[84:87], v[64:79]
    v_mfma_f32_32x32x16_bf16 v[16:31], v[104:107], v[96:99], v[16:31]
    ds_read_b128 v[80:83], v129 offset:32768
    ds_read_b64_tr_b16 v[88:89], v140 offset:18432
    v_mfma_f32_32x32x16_bf16 v[32:47], v[108:111], v[96:99], v[32:47]
    ds_read_b64_tr_b16 v[90:91], v140 offset:18944
    ds_read_b64_tr_b16 v[92:93], v140 offset:26624
    v_mfma_f32_32x32x16_bf16 v[48:63], v[104:107], v[100:103], v[48:63]
    ds_read_b64_tr_b16 v[94:95], v140 offset:27136
    ds_read_b128 v[84:87], v129 offset:36864
    v_mfma_f32_32x32x16_bf16 v[64:79], v[108:111], v[100:103], v[64:79]
    s_waitcnt lgkmcnt(6)
    v_mfma_f32_32x32x16_bf16 v[16:31], v[120:123], v[112:115], v[16:31]
    ds_read_b128 v[96:99], v130 offset:32768
    ds_read_b64_tr_b16 v[104:105], v141 offset:16384
    v_mfma_f32_32x32x16_bf16 v[32:47], v[124:127], v[112:115], v[32:47]
    ds_read_b64_tr_b16 v[106:107], v141 offset:16896
    ds_read_b64_tr_b16 v[108:109], v141 offset:24576
    v_mfma_f32_32x32x16_bf16 v[48:63], v[120:123], v[116:119], v[48:63]
    ds_read_b64_tr_b16 v[110:111], v141 offset:25088
    ds_read_b128 v[100:103], v130 offset:36864
    v_mfma_f32_16x16x32_bf16 v[156:159], v[148:151], v[120:123], v[156:159]
    v_mfma_f32_32x32x16_bf16 v[64:79], v[124:127], v[116:119], v[64:79]
    v_mfma_f32_16x16x32_bf16 v[156:159], v[152:155], v[124:127], v[156:159]
    s_waitcnt lgkmcnt(6)
    v_mfma_f32_32x32x16_bf16 v[16:31], v[88:91], v[80:83], v[16:31]
    ds_read_b128 v[112:115], v131 offset:32768
    ds_read_b64_tr_b16 v[120:121], v141 offset:18432
    v_mfma_f32_32x32x16_bf16 v[32:47], v[92:95], v[80:83], v[32:47]
    ds_read_b64_tr_b16 v[122:123], v141 offset:18944
    ds_read_b64_tr_b16 v[124:125], v141 offset:26624
    v_mfma_f32_32x32x16_bf16 v[48:63], v[88:91], v[84:87], v[48:63]
    ds_read_b64_tr_b16 v[126:127], v141 offset:27136
    ds_read_b128 v[116:119], v131 offset:36864
    v_mfma_f32_16x16x32_bf16 v[156:159], v[148:151], v[88:91], v[156:159]
    v_mfma_f32_32x32x16_bf16 v[64:79], v[92:95], v[84:87], v[64:79]
    v_mfma_f32_16x16x32_bf16 v[156:159], v[152:155], v[92:95], v[156:159]
    s_waitcnt lgkmcnt(6)
    v_mfma_f32_32x32x16_bf16 v[16:31], v[104:107], v[96:99], v[16:31]
    s_waitcnt lgkmcnt(0)
    s_barrier
    ds_read_b128 v[80:83], v132 offset:16384
    ds_read_b64_tr_b16 v[88:89], v142 offset:0
    v_mfma_f32_32x32x16_bf16 v[32:47], v[108:111], v[96:99], v[32:47]
    ds_read_b64_tr_b16 v[90:91], v142 offset:512
    ds_read_b64_tr_b16 v[92:93], v142 offset:8192
    v_mfma_f32_32x32x16_bf16 v[48:63], v[104:107], v[100:103], v[48:63]
    ds_read_b64_tr_b16 v[94:95], v142 offset:8704
    ds_read_b128 v[84:87], v132 offset:20480
    v_mfma_f32_32x32x16_bf16 v[64:79], v[108:111], v[100:103], v[64:79]
    v_mfma_f32_32x32x16_bf16 v[16:31], v[120:123], v[112:115], v[16:31]
    ds_read_b128 v[96:99], v133 offset:16384
    ds_read_b64_tr_b16 v[104:105], v142 offset:2048
    v_mfma_f32_32x32x16_bf16 v[32:47], v[124:127], v[112:115], v[32:47]
    ds_read_b64_tr_b16 v[106:107], v142 offset:2560
    ds_read_b64_tr_b16 v[108:109], v142 offset:10240
    v_mfma_f32_32x32x16_bf16 v[48:63], v[120:123], v[116:119], v[48:63]
    ds_read_b64_tr_b16 v[110:111], v142 offset:10752
    ds_read_b128 v[100:103], v133 offset:20480
    v_mfma_f32_32x32x16_bf16 v[64:79], v[124:127], v[116:119], v[64:79]
    s_waitcnt lgkmcnt(6)
    v_mfma_f32_32x32x16_bf16 v[16:31], v[88:91], v[80:83], v[16:31]
    ds_read_b128 v[112:115], v134 offset:16384
    ds_read_b64_tr_b16 v[120:121], v143 offset:0
    v_mfma_f32_32x32x16_bf16 v[32:47], v[92:95], v[80:83], v[32:47]
    ds_read_b64_tr_b16 v[122:123], v143 offset:512
    ds_read_b64_tr_b16 v[124:125], v143 offset:8192
    v_mfma_f32_32x32x16_bf16 v[48:63], v[88:91], v[84:87], v[48:63]
    ds_read_b64_tr_b16 v[126:127], v143 offset:8704
    ds_read_b128 v[116:119], v134 offset:20480
    v_mfma_f32_16x16x32_bf16 v[156:159], v[148:151], v[88:91], v[156:159]
    v_mfma_f32_32x32x16_bf16 v[64:79], v[92:95], v[84:87], v[64:79]
    v_mfma_f32_16x16x32_bf16 v[156:159], v[152:155], v[92:95], v[156:159]
    s_waitcnt lgkmcnt(6)
    v_mfma_f32_32x32x16_bf16 v[16:31], v[104:107], v[96:99], v[16:31]
    ds_read_b128 v[80:83], v135 offset:16384
    ds_read_b64_tr_b16 v[88:89], v143 offset:2048
    v_mfma_f32_32x32x16_bf16 v[32:47], v[108:111], v[96:99], v[32:47]
    ds_read_b64_tr_b16 v[90:91], v143 offset:2560
    ds_read_b64_tr_b16 v[92:93], v143 offset:10240
    v_mfma_f32_32x32x16_bf16 v[48:63], v[104:107], v[100:103], v[48:63]
    ds_read_b64_tr_b16 v[94:95], v143 offset:10752
    ds_read_b128 v[84:87], v135 offset:20480
    v_mfma_f32_16x16x32_bf16 v[156:159], v[148:151], v[104:107], v[156:159]
    v_mfma_f32_32x32x16_bf16 v[64:79], v[108:111], v[100:103], v[64:79]
    v_mfma_f32_16x16x32_bf16 v[156:159], v[152:155], v[108:111], v[156:159]
    s_waitcnt lgkmcnt(6)
    v_mfma_f32_32x32x16_bf16 v[16:31], v[120:123], v[112:115], v[16:31]
    s_waitcnt lgkmcnt(0)
    s_barrier
    ds_read_b128 v[96:99], v136 offset:32768
    ds_read_b64_tr_b16 v[104:105], v144 offset:0
    v_mfma_f32_32x32x16_bf16 v[32:47], v[124:127], v[112:115], v[32:47]
    ds_read_b64_tr_b16 v[106:107], v144 offset:512
    ds_read_b64_tr_b16 v[108:109], v144 offset:8192
    v_mfma_f32_32x32x16_bf16 v[48:63], v[120:123], v[116:119], v[48:63]
    ds_read_b64_tr_b16 v[110:111], v144 offset:8704
    ds_read_b128 v[100:103], v136 offset:36864
    v_mfma_f32_32x32x16_bf16 v[64:79], v[124:127], v[116:119], v[64:79]
    buffer_load_dwordx2 v[146:147], v171, s[20:23], 0 offen sc1
    v_mfma_f32_32x32x16_bf16 v[16:31], v[88:91], v[80:83], v[16:31]
    ds_read_b128 v[112:115], v137 offset:32768
    ds_read_b64_tr_b16 v[120:121], v144 offset:2048
    v_mfma_f32_32x32x16_bf16 v[32:47], v[92:95], v[80:83], v[32:47]
    ds_read_b64_tr_b16 v[122:123], v144 offset:2560
    ds_read_b64_tr_b16 v[124:125], v144 offset:10240
    v_mfma_f32_32x32x16_bf16 v[48:63], v[88:91], v[84:87], v[48:63]
    ds_read_b64_tr_b16 v[126:127], v144 offset:10752
    ds_read_b128 v[116:119], v137 offset:36864
    v_mfma_f32_32x32x16_bf16 v[64:79], v[92:95], v[84:87], v[64:79]
    s_waitcnt lgkmcnt(6)
    v_mfma_f32_32x32x16_bf16 v[16:31], v[104:107], v[96:99], v[16:31]
    ds_read_b128 v[80:83], v138 offset:32768
    ds_read_b64_tr_b16 v[88:89], v145 offset:0
    v_mfma_f32_32x32x16_bf16 v[32:47], v[108:111], v[96:99], v[32:47]
    ds_read_b64_tr_b16 v[90:91], v145 offset:512
    ds_read_b64_tr_b16 v[92:93], v145 offset:8192
    v_mfma_f32_32x32x16_bf16 v[48:63], v[104:107], v[100:103], v[48:63]
    ds_read_b64_tr_b16 v[94:95], v145 offset:8704
    ds_read_b128 v[84:87], v138 offset:36864
    v_mfma_f32_16x16x32_bf16 v[156:159], v[148:151], v[104:107], v[156:159]
    v_mfma_f32_32x32x16_bf16 v[64:79], v[108:111], v[100:103], v[64:79]
    v_mfma_f32_16x16x32_bf16 v[156:159], v[152:155], v[108:111], v[156:159]
    s_waitcnt lgkmcnt(6)
    v_mfma_f32_32x32x16_bf16 v[16:31], v[120:123], v[112:115], v[16:31]
    ds_read_b128 v[96:99], v139 offset:32768
    ds_read_b64_tr_b16 v[104:105], v145 offset:2048
    v_mfma_f32_32x32x16_bf16 v[32:47], v[124:127], v[112:115], v[32:47]
    ds_read_b64_tr_b16 v[106:107], v145 offset:2560
    ds_read_b64_tr_b16 v[108:109], v145 offset:10240
    v_mfma_f32_32x32x16_bf16 v[48:63], v[120:123], v[116:119], v[48:63]
    ds_read_b64_tr_b16 v[110:111], v145 offset:10752
    ds_read_b128 v[100:103], v139 offset:36864
    v_mfma_f32_16x16x32_bf16 v[156:159], v[148:151], v[120:123], v[156:159]
    v_mfma_f32_32x32x16_bf16 v[64:79], v[124:127], v[116:119], v[64:79]
    v_mfma_f32_16x16x32_bf16 v[156:159], v[152:155], v[124:127], v[156:159]
    s_waitcnt lgkmcnt(6)
    v_mfma_f32_32x32x16_bf16 v[16:31], v[88:91], v[80:83], v[16:31]
    s_nop 5
    ds_write_b32 v168, v156
    s_waitcnt lgkmcnt(0)
    s_barrier
    ds_read_b32 v136, v169
    ds_read_b32 v137, v169 offset:128
    v_mov_b32 v129, 0
    v_mov_b32 v130, 0
    v_mov_b32 v131, 0
    v_mfma_f32_32x32x16_bf16 v[32:47], v[92:95], v[80:83], v[32:47]
    v_mov_b32 v133, 0
    v_mov_b32 v134, 0
    v_mov_b32 v135, 0
    v_mfma_f32_32x32x16_bf16 v[48:63], v[88:91], v[84:87], v[48:63]
    v_mfma_f32_32x32x16_bf16 v[64:79], v[92:95], v[84:87], v[64:79]
    v_mfma_f32_32x32x16_bf16 v[16:31], v[104:107], v[96:99], v[16:31]
    s_waitcnt lgkmcnt(0)
    v_cvt_pk_bf16_f32 v138, v136, v136
    v_and_b32 v138, s66, v138
    v_sub_f32 v138, v136, v138
    v_mfma_f32_32x32x16_bf16 v[32:47], v[108:111], v[96:99], v[32:47]
    v_cvt_pk_bf16_f32 v128, v136, v138
    v_cvt_pk_bf16_f32 v139, v137, v137
    v_and_b32 v139, s66, v139
    v_mfma_f32_32x32x16_bf16 v[48:63], v[104:107], v[100:103], v[48:63]
    v_sub_f32 v139, v137, v139
    v_cvt_pk_bf16_f32 v132, v137, v139
    v_mfma_f32_32x32x16_bf16 v[64:79], v[108:111], v[100:103], v[64:79]
    s_setprio 0
    s_waitcnt vmcnt(0)
    v_cmp_ne_u32 s[78:79], v147, v14
    s_cmp_lg_u64 s[78:79], 0
    s_cbranch_scc1 L_ts29
L_tb28:
    s_add_u32 m0, s57, 98304
    s_mov_b32 s53, 917632
    buffer_load_dwordx4 v164, s[12:15], s53 offen lds
    v_and_b32 v182, 0xffff, v146
    v_and_b32 v4, s66, v146
    v_xor_b32 v182, 0x8000, v182
    v_rcp_f32 v5, v4
    v_lshl_or_b32 v182, v182, 16, v182
    v_mul_f32 v176, v4, v4
    v_mul_f32 v178, 0xc0135761, v5
    v_mul_f32 v4, v5, v5
    v_mul_f32 v4, v4, v5
    v_mul_f32 v180, 0xbdd2d3e8, v4
    v_mov_b32 v184, v182
    s_add_u32 m0, s57, 106496
    s_nop 0
    buffer_load_dwordx4 v164, s[16:19], s53 offen lds
    v_mov_b32 v177, v176
    v_mov_b32 v179, v178
    v_mov_b32 v181, v180
    s_nop 1
    v_permlane32_swap_b32 v182, v184
    v_permlane32_swap_b32 v176, v177
    v_permlane32_swap_b32 v178, v179
    v_permlane32_swap_b32 v180, v181
    v_mfma_f32_32x32x16_bf16 v[16:31], v[128:131], v[182:185], v[16:31]
    v_mfma_f32_32x32x16_bf16 v[32:47], v[132:135], v[182:185], v[32:47]
    v_mfma_f32_32x32x16_bf16 v[48:63], v[128:131], v[184:187], v[48:63]
    s_add_u32 m0, s57, 102400
    s_mov_b32 s53, 1032320
    buffer_load_dwordx4 v164, s[12:15], s53 offen lds
    v_mfma_f32_32x32x16_bf16 v[64:79], v[132:135], v[184:187], v[64:79]
    s_nop 9
    v_mul_f32 v112, v16, v16
    v_mul_f32 v113, v17, v17
    v_mul_f32 v114, v18, v18
    v_mul_f32 v115, v19, v19
    v_mul_f32 v116, v20, v20
    v_mul_f32 v117, v21, v21
    v_mul_f32 v118, v22, v22
    v_mul_f32 v119, v23, v23
    v_fma_f32 v112, v112, v180, v178
    s_add_u32 m0, s57, 110592
    s_nop 0
    buffer_load_dwordx4 v164, s[16:19], s53 offen lds
    v_fma_f32 v113, v113, v180, v178
    v_fma_f32 v114, v114, v180, v178
    v_fma_f32 v115, v115, v180, v178
    v_fma_f32 v116, v116, v180, v178
    v_fma_f32 v117, v117, v180, v178
    v_fma_f32 v118, v118, v180, v178
    v_fma_f32 v119, v119, v180, v178
    v_mul_f32 v112, v112, v16
    v_mul_f32 v113, v113, v17
    v_mul_f32 v114, v114, v18
    v_mul_f32 v115, v115, v19
    buffer_load_dwordx2 v[190:191], v174, s[20:23], 0 offen sc1
    s_barrier
    s_add_u32 m0, s57, 16384
    s_mov_b32 s53, 1147008
    buffer_load_dwordx4 v164, s[12:15], s53 offen lds
    v_mul_f32 v116, v116, v20
    v_mul_f32 v117, v117, v21
    v_mul_f32 v118, v118, v22
    v_mul_f32 v119, v119, v23
    v_exp_f32 v112, v112
    v_mul_f32 v16, v16, v32
    s_add_u32 m0, s57, 24576
    s_nop 0
    buffer_load_dwordx4 v164, s[16:19], s53 offen lds
    v_exp_f32 v113, v113
    v_mul_f32 v17, v17, v33
    v_exp_f32 v114, v114
    v_mul_f32 v18, v18, v34
    v_exp_f32 v115, v115
    v_mul_f32 v19, v19, v35
    v_exp_f32 v116, v116
    s_add_u32 m0, s57, 20480
    s_mov_b32 s53, 1261696
    buffer_load_dwordx4 v164, s[12:15], s53 offen lds
    v_mul_f32 v20, v20, v36
    v_exp_f32 v117, v117
    v_mul_f32 v21, v21, v37
    v_exp_f32 v118, v118
    v_mul_f32 v22, v22, v38
    v_exp_f32 v119, v119
    v_mul_f32 v23, v23, v39
    s_add_u32 m0, s57, 28672
    s_nop 0
    buffer_load_dwordx4 v164, s[16:19], s53 offen lds
    v_fma_f32 v112, v112, v176, v176
    v_fma_f32 v113, v113, v176, v176
    v_fma_f32 v114, v114, v176, v176
    v_fma_f32 v115, v115, v176, v176
    v_fma_f32 v116, v116, v176, v176
    v_fma_f32 v117, v117, v176, v176
    v_fma_f32 v118, v118, v176, v176
    s_add_u32 m0, s57, 81920
    s_mov_b32 s53, 1376384
    buffer_load_dwordx4 v164, s[12:15], s53 offen lds
    v_fma_f32 v119, v119, v176, v176
    v_rcp_f32 v112, v112
    v_rcp_f32 v113, v113
    v_rcp_f32 v114, v114
    v_rcp_f32 v115, v115
    v_rcp_f32 v116, v116
    s_add_u32 m0, s57, 90112
    s_nop 0
    buffer_load_dwordx4 v164, s[16:19], s53 offen lds
    v_rcp_f32 v117, v117
    v_rcp_f32 v118, v118
    v_rcp_f32 v119, v119
    v_mul_f32 v16, v16, v112
    v_mul_f32 v17, v17, v113
    v_mul_f32 v18, v18, v114
    v_mul_f32 v19, v19, v115
    s_add_u32 m0, s57, 86016
    s_mov_b32 s53, 1491072
    buffer_load_dwordx4 v164, s[12:15], s53 offen lds
    v_mul_f32 v20, v20, v116
    v_mul_f32 v21, v21, v117
    v_mul_f32 v22, v22, v118
    v_mul_f32 v23, v23, v119
    v_cvt_pk_bf16_f32 v120, v16, v17
    v_cvt_pk_bf16_f32 v121, v18, v19
    v_cvt_pk_bf16_f32 v122, v20, v21
    s_add_u32 m0, s57, 94208
    s_nop 0
    buffer_load_dwordx4 v164, s[16:19], s53 offen lds
    v_cvt_pk_bf16_f32 v123, v22, v23
    buffer_store_dwordx4 v[120:123], v6, s[20:23], s74 offen offset:0 sc1
    v_mul_f32 v112, v24, v24
    v_mul_f32 v113, v25, v25
    v_mul_f32 v114, v26, v26
    v_mul_f32 v115, v27, v27
    v_mul_f32 v116, v28, v28
    s_waitcnt vmcnt(10)
    s_barrier
    s_waitcnt vmcnt(9)
    v_cmp_ne_u64 s[78:79], v[190:191], v[14:15]
    s_cmp_lg_u64 s[78:79], 0
    s_cbranch_scc1 L_ts32
L_tb31:
    s_add_u32 m0, s57, 49152
    s_mov_b32 s53, 1605760
    buffer_load_dwordx4 v164, s[12:15], s53 offen lds
    v_mul_f32 v117, v29, v29
    v_mul_f32 v118, v30, v30
    v_mul_f32 v119, v31, v31
    v_fma_f32 v112, v112, v180, v178
    v_fma_f32 v113, v113, v180, v178
    v_fma_f32 v114, v114, v180, v178
    s_add_u32 m0, s57, 57344
    s_nop 0
    buffer_load_dwordx4 v164, s[16:19], s53 offen lds
    v_fma_f32 v115, v115, v180, v178
    v_fma_f32 v116, v116, v180, v178
    v_fma_f32 v117, v117, v180, v178
    v_fma_f32 v118, v118, v180, v178
    v_fma_f32 v119, v119, v180, v178
    v_mul_f32 v112, v112, v24
    v_mul_f32 v113, v113, v25
    s_add_u32 m0, s57, 53248
    s_mov_b32 s53, 1720448
    buffer_load_dwordx4 v164, s[12:15], s53 offen lds
    v_mul_f32 v114, v114, v26
    v_mul_f32 v115, v115, v27
    v_mul_f32 v116, v116, v28
    v_mul_f32 v117, v117, v29
    v_mul_f32 v118, v118, v30
    v_mul_f32 v119, v119, v31
    v_exp_f32 v112, v112
    s_add_u32 m0, s57, 61440
    s_nop 0
    buffer_load_dwordx4 v164, s[16:19], s53 offen lds
    v_mul_f32 v24, v24, v40
    v_exp_f32 v113, v113
    v_mul_f32 v25, v25, v41
    v_exp_f32 v114, v114
    v_mul_f32 v26, v26, v42
    v_exp_f32 v115, v115
    v_mul_f32 v27, v27, v43
    s_add_u32 m0, s57, 114688
    s_mov_b32 s53, 128
    buffer_load_dwordx4 v164, s[12:15], s53 offen lds
    v_exp_f32 v116, v116
    v_mul_f32 v28, v28, v44
    v_exp_f32 v117, v117
    v_mul_f32 v29, v29, v45
    v_exp_f32 v118, v118
    v_mul_f32 v30, v30, v46
    s_add_u32 m0, s57, 122880
    s_nop 0
    buffer_load_dwordx4 v164, s[16:19], s53 offen lds
    v_exp_f32 v119, v119
    v_mul_f32 v31, v31, v47
    v_fma_f32 v112, v112, v176, v176
    v_fma_f32 v113, v113, v176, v176
    v_fma_f32 v114, v114, v176, v176
    v_fma_f32 v115, v115, v176, v176
    v_fma_f32 v116, v116, v176, v176
    s_add_u32 m0, s57, 118784
    s_mov_b32 s53, 114816
    buffer_load_dwordx4 v164, s[12:15], s53 offen lds
    v_fma_f32 v117, v117, v176, v176
    v_fma_f32 v118, v118, v176, v176
    v_fma_f32 v119, v119, v176, v176
    v_rcp_f32 v112, v112
    v_rcp_f32 v113, v113
    v_rcp_f32 v114, v114
    v_rcp_f32 v115, v115
    s_add_u32 m0, s57, 126976
    s_nop 0
    buffer_load_dwordx4 v164, s[16:19], s53 offen lds
    v_rcp_f32 v116, v116
    v_rcp_f32 v117, v117
    v_rcp_f32 v118, v118
    v_rcp_f32 v119, v119
    v_mul_f32 v24, v24, v112
    v_mul_f32 v25, v25, v113
    v_mul_f32 v26, v26, v114
    s_waitcnt vmcnt(13)
    s_barrier
    s_mov_b32 m0, s57
    s_movk_i32 s56, 0
    buffer_load_dwordx4 v160, s[4:7], s56 offen lds
    v_mul_f32 v27, v27, v115
    v_mul_f32 v28, v28, v116
    v_mul_f32 v29, v29, v117
    v_mul_f32 v30, v30, v118
    v_mul_f32 v31, v31, v119
    v_cvt_pk_bf16_f32 v124, v24, v25
    v_cvt_pk_bf16_f32 v125, v26, v27
    v_cvt_pk_bf16_f32 v126, v28, v29
    v_cvt_pk_bf16_f32 v127, v30, v31
    buffer_store_dwordx4 v[124:127], v6, s[20:23], s74 offen offset:1024 sc1
    s_add_u32 m0, s57, 4096
    s_nop 0
    buffer_load_dwordx4 v161, s[4:7], s56 offen lds
    v_mul_f32 v112, v48, v48
    v_mul_f32 v113, v49, v49
    v_mul_f32 v114, v50, v50
    v_mul_f32 v115, v51, v51
    v_mul_f32 v116, v52, v52
    v_mul_f32 v117, v53, v53
    v_mul_f32 v118, v54, v54
    v_mul_f32 v119, v55, v55
    v_fma_f32 v112, v112, v181, v179
    v_fma_f32 v113, v113, v181, v179
    v_fma_f32 v114, v114, v181, v179
    s_add_u32 m0, s57, 8192
    s_nop 0
    buffer_load_dwordx4 v162, s[4:7], s56 offen lds
    v_fma_f32 v115, v115, v181, v179
    v_fma_f32 v116, v116, v181, v179
    v_fma_f32 v117, v117, v181, v179
    v_fma_f32 v118, v118, v181, v179
    v_fma_f32 v119, v119, v181, v179
    v_mul_f32 v112, v112, v48
    v_mul_f32 v113, v113, v49
    v_mul_f32 v114, v114, v50
    v_mul_f32 v115, v115, v51
    v_mul_f32 v116, v116, v52
    v_mul_f32 v117, v117, v53
    s_add_u32 m0, s57, 12288
    s_nop 0
    buffer_load_dwordx4 v163, s[4:7], s56 offen lds
    v_mul_f32 v118, v118, v54
    v_mul_f32 v119, v119, v55
    v_exp_f32 v112, v112
    v_mul_f32 v48, v48, v64
    v_exp_f32 v113, v113
    v_mul_f32 v49, v49, v65
    v_exp_f32 v114, v114
    v_mul_f32 v50, v50, v66
    v_exp_f32 v115, v115
    v_mul_f32 v51, v51, v67
    v_exp_f32 v116, v116
    buffer_load_dwordx4 v[192:195], v6, s[20:23], s51 offen offset:0 sc1
    v_mul_f32 v52, v52, v68
    v_exp_f32 v117, v117
    v_mul_f32 v53, v53, v69
    v_exp_f32 v118, v118
    v_mul_f32 v54, v54, v70
    v_exp_f32 v119, v119
    v_mul_f32 v55, v55, v71
    v_fma_f32 v112, v112, v177, v177
    v_fma_f32 v113, v113, v177, v177
    v_fma_f32 v114, v114, v177, v177
    v_fma_f32 v115, v115, v177, v177
    buffer_load_dwordx4 v[196:199], v6, s[20:23], s51 offen offset:1024 sc1
    v_fma_f32 v116, v116, v177, v177
    v_fma_f32 v117, v117, v177, v177
    v_fma_f32 v118, v118, v177, v177
    v_fma_f32 v119, v119, v177, v177
    v_rcp_f32 v112, v112
    v_rcp_f32 v113, v113
    v_rcp_f32 v114, v114
    v_rcp_f32 v115, v115
    v_rcp_f32 v116, v116
    v_rcp_f32 v117, v117
    v_rcp_f32 v118, v118
    s_waitcnt vmcnt(16)
    s_barrier
    s_add_u32 m0, s57, 98304
    s_mov_b32 s53, 229504
    buffer_load_dwordx4 v164, s[12:15], s53 offen lds
    v_rcp_f32 v119, v119
    v_mul_f32 v48, v48, v112
    v_mul_f32 v49, v49, v113
    v_mul_f32 v50, v50, v114
    v_mul_f32 v51, v51, v115
    v_mul_f32 v52, v52, v116
    v_mul_f32 v53, v53, v117
    v_mul_f32 v54, v54, v118
    s_add_u32 m0, s57, 106496
    s_nop 0
    buffer_load_dwordx4 v164, s[16:19], s53 offen lds
    v_mul_f32 v55, v55, v119
    v_cvt_pk_bf16_f32 v120, v48, v49
    v_cvt_pk_bf16_f32 v121, v50, v51
    v_cvt_pk_bf16_f32 v122, v52, v53
    v_cvt_pk_bf16_f32 v123, v54, v55
    buffer_store_dwordx4 v[120:123], v6, s[20:23], s75 offen offset:0 sc1
    v_mul_f32 v112, v56, v56
    v_mul_f32 v113, v57, v57
    s_add_u32 m0, s57, 102400
    s_mov_b32 s53, 344192
    buffer_load_dwordx4 v164, s[12:15], s53 offen lds
    v_mul_f32 v114, v58, v58
    v_mul_f32 v115, v59, v59
    v_mul_f32 v116, v60, v60
    v_mul_f32 v117, v61, v61
    v_mul_f32 v118, v62, v62
    v_mul_f32 v119, v63, v63
    v_fma_f32 v112, v112, v181, v179
    v_fma_f32 v113, v113, v181, v179
    v_fma_f32 v114, v114, v181, v179
    s_add_u32 m0, s57, 110592
    s_nop 0
    buffer_load_dwordx4 v164, s[16:19], s53 offen lds
    v_fma_f32 v115, v115, v181, v179
    v_fma_f32 v116, v116, v181, v179
    v_fma_f32 v117, v117, v181, v179
    v_fma_f32 v118, v118, v181, v179
    v_fma_f32 v119, v119, v181, v179
    v_mul_f32 v112, v112, v56
    v_mul_f32 v113, v113, v57
    v_mul_f32 v114, v114, v58
    buffer_load_dwordx4 v[200:203], v6, s[20:23], s51 offen offset:2048 sc1
    v_mul_f32 v115, v115, v59
    v_mul_f32 v116, v116, v60
    v_mul_f32 v117, v117, v61
    v_mul_f32 v118, v118, v62
    v_mul_f32 v119, v119, v63
    v_exp_f32 v112, v112
    v_mul_f32 v56, v56, v72
    v_exp_f32 v113, v113
    buffer_load_dwordx4 v[204:207], v6, s[20:23], s51 offen offset:3072 sc1
    s_add_u32 s51, s51, 4096
    v_mul_f32 v57, v57, v73
    v_exp_f32 v114, v114
    v_mul_f32 v58, v58, v74
    v_exp_f32 v115, v115
    v_mul_f32 v59, v59, v75
    v_exp_f32 v116, v116
    v_mul_f32 v60, v60, v76
    v_exp_f32 v117, v117
    v_mul_f32 v61, v61, v77
    buffer_load_dwordx4 v[208:211], v6, s[20:23], s51 offen offset:0 sc1
    v_exp_f32 v118, v118
    v_mul_f32 v62, v62, v78
    v_exp_f32 v119, v119
    v_mul_f32 v63, v63, v79
    v_fma_f32 v112, v112, v177, v177
    v_fma_f32 v113, v113, v177, v177
    v_fma_f32 v114, v114, v177, v177
    v_fma_f32 v115, v115, v177, v177
    buffer_load_dwordx4 v[212:215], v6, s[20:23], s51 offen offset:1024 sc1
    v_fma_f32 v116, v116, v177, v177
    v_fma_f32 v117, v117, v177, v177
    v_fma_f32 v118, v118, v177, v177
    v_fma_f32 v119, v119, v177, v177
    v_rcp_f32 v112, v112
    v_rcp_f32 v113, v113
    v_rcp_f32 v114, v114
    v_rcp_f32 v115, v115
    v_rcp_f32 v116, v116
    s_waitcnt vmcnt(20)
    s_barrier
    s_add_u32 m0, s57, 16384
    s_movk_i32 s56, 128
    buffer_load_dwordx4 v160, s[4:7], s56 offen lds
    v_rcp_f32 v117, v117
    s_add_u32 m0, s57, 20480
    s_nop 0
    buffer_load_dwordx4 v161, s[4:7], s56 offen lds
    v_rcp_f32 v118, v118
    v_rcp_f32 v119, v119
    s_add_u32 m0, s57, 24576
    s_nop 0
    buffer_load_dwordx4 v162, s[4:7], s56 offen lds
    v_mul_f32 v56, v56, v112
    s_add_u32 m0, s57, 28672
    s_nop 0
    buffer_load_dwordx4 v163, s[4:7], s56 offen lds
    v_mul_f32 v57, v57, v113
    v_mul_f32 v58, v58, v114
    buffer_load_dwordx4 v[216:219], v6, s[20:23], s51 offen offset:2048 sc1
    v_mul_f32 v59, v59, v115
    v_mul_f32 v60, v60, v116
    buffer_load_dwordx4 v[220:223], v6, s[20:23], s51 offen offset:3072 sc1
    s_add_u32 s51, s51, 4096
    v_mul_f32 v61, v61, v117
    buffer_load_dwordx4 v[224:227], v6, s[20:23], s51 offen offset:0 sc1
    v_mul_f32 v62, v62, v118
    v_mul_f32 v63, v63, v119
    buffer_load_dwordx4 v[228:231], v6, s[20:23], s51 offen offset:1024 sc1
    v_cvt_pk_bf16_f32 v124, v56, v57
    buffer_load_dwordx4 v[232:235], v6, s[20:23], s51 offen offset:2048 sc1
    v_cvt_pk_bf16_f32 v125, v58, v59
    v_cvt_pk_bf16_f32 v126, v60, v61
    buffer_load_dwordx4 v[236:239], v6, s[20:23], s51 offen offset:3072 sc1
    s_add_u32 s51, s51, 4096
    v_cvt_pk_bf16_f32 v127, v62, v63
    buffer_store_dwordx4 v[124:127], v6, s[20:23], s75 offen offset:1024 sc1
    s_waitcnt vmcnt(22)
    s_barrier
    buffer_load_dwordx4 v[240:243], v6, s[20:23], s51 offen offset:0 sc1
    buffer_load_dwordx4 v[244:247], v6, s[20:23], s51 offen offset:1024 sc1
    buffer_load_dwordx4 v[248:251], v6, s[20:23], s51 offen offset:2048 sc1
    buffer_load_dwordx4 v[252:255], v6, s[20:23], s51 offen offset:3072 sc1
    s_add_u32 s51, s51, 4096
    buffer_load_dwordx4 v[80:83], v6, s[20:23], s51 offen offset:0 sc1
    buffer_load_dwordx4 v[84:87], v6, s[20:23], s51 offen offset:1024 sc1
    buffer_load_dwordx4 v[88:91], v6, s[20:23], s51 offen offset:2048 sc1
    buffer_load_dwordx4 v[92:95], v6, s[20:23], s51 offen offset:3072 sc1
    s_add_u32 s51, s51, 4096
    s_waitcnt vmcnt(8)
    v_mov_b32 v2, 147456
    v_mov_b32 v3, 1
    s_mov_b64 exec, 1
    ds_add_rtn_u32 v3, v2, v3
    s_waitcnt lgkmcnt(0)
    v_readfirstlane_b32 s73, v3
    s_mov_b64 exec, -1
    s_cmp_lg_u32 s73, s3
    s_cbranch_scc1 L_ar34
    s_atomic_swap_x2 s[34:35], s[30:31], s55
L_ar34:
    s_waitcnt vmcnt(15)
    s_barrier
    buffer_load_dwordx4 v[96:99], v6, s[20:23], s51 offen offset:0 sc1
    buffer_load_dwordx4 v[100:103], v6, s[20:23], s51 offen offset:1024 sc1
    buffer_load_dwordx4 v[104:107], v6, s[20:23], s51 offen offset:2048 sc1
    buffer_load_dwordx4 v[108:111], v6, s[20:23], s51 offen offset:3072 sc1
    s_add_u32 s51, s51, 4096
    buffer_load_dwordx4 v[112:115], v6, s[20:23], s51 offen offset:0 sc1
    buffer_load_dwordx4 v[116:119], v6, s[20:23], s51 offen offset:1024 sc1
    buffer_load_dwordx4 v[120:123], v6, s[20:23], s51 offen offset:2048 sc1
    buffer_load_dwordx4 v[124:127], v6, s[20:23], s51 offen offset:3072 sc1
    s_add_u32 s51, s51, 4096
    s_mov_b32 s8, s26
    s_mov_b32 s9, s27
    s_mov_b32 s10, 2097152
    s_mov_b32 s11, 0x20000
    s_and_b32 s65, s68, 1
    s_lshl_b32 s72, s65, 9
    s_add_u32 s72, s72, s70
    s_lshl_b32 s72, s72, 10
    s_lshl_b32 s64, s69, 7
    s_add_u32 s72, s72, s64
    v_bfe_u32 v2, v0, 3, 5
    v_lshrrev_b32 v3, 8, v0
    v_lshlrev_b32 v7, 14, v2
    v_lshl_add_u32 v7, v3, 20, v7
    v_and_b32 v3, 7, v0
    v_lshl_add_u32 v7, v3, 4, v7
    v_add_u32 v5, 229376, v6
    s_lshl_b32 s64, s70, 2
    s_add_u32 s64, s64, s65
    s_mul_i32 s64, s64, 114688
    s_lshl_b32 s65, s50, 15
    s_add_u32 s64, s64, s65
    s_cmp_ge_u32 s50, 4
    s_cselect_b32 s65, 110592, 0
    s_sub_u32 s74, s64, s65
    s_cmp_ge_u32 s50, 4
    s_cselect_b32 s65, 110592, 0
    s_sub_u32 s75, s64, s65
    s_add_u32 s75, s75, 8192
    s_cmp_ge_u32 s50, 3
    s_cselect_b32 s65, 110592, 0
    s_sub_u32 s76, s64, s65
    s_add_u32 s76, s76, 16384
    s_cmp_ge_u32 s50, 3
    s_cselect_b32 s65, 110592, 0
    s_sub_u32 s77, s64, s65
    s_add_u32 s77, s77, 24576
    s_barrier
    buffer_load_dwordx4 v[128:131], v6, s[20:23], s51 offen offset:0 sc1
    buffer_load_dwordx4 v[132:135], v6, s[20:23], s51 offen offset:1024 sc1
    buffer_load_dwordx4 v[136:139], v6, s[20:23], s51 offen offset:2048 sc1
    buffer_load_dwordx4 v[140:143], v6, s[20:23], s51 offen offset:3072 sc1
    s_add_u32 s51, s51, 4096
    s_branch L_go
L_g1:
    s_mov_b32 m0, s57
    s_mov_b32 s53, 0
    buffer_load_dwordx4 v164, s[12:15], s53 offen lds
    s_add_u32 m0, s57, 8192
    s_nop 0
    buffer_load_dwordx4 v164, s[16:19], s53 offen lds
    s_add_u32 m0, s57, 4096
    s_mov_b32 s53, 114688
    buffer_load_dwordx4 v164, s[12:15], s53 offen lds
    s_add_u32 m0, s57, 12288
    s_nop 0
    buffer_load_dwordx4 v164, s[16:19], s53 offen lds
    s_add_u32 m0, s57, 16384
    s_movk_i32 s56, 0
    buffer_load_dwordx4 v160, s[4:7], s56 offen lds
    s_add_u32 m0, s57, 20480
    s_nop 0
    buffer_load_dwordx4 v161, s[4:7], s56 offen lds
    s_add_u32 m0, s57, 24576
    s_nop 0
    buffer_load_dwordx4 v162, s[4:7], s56 offen lds
    s_add_u32 m0, s57, 28672
    s_nop 0
    buffer_load_dwordx4 v163, s[4:7], s56 offen lds
    v_and_b32 v4, 31, v1
    s_lshl_b32 s64, s48, 5
    v_add_u32 v5, s64, v4
    v_mul_lo_u32 v5, v5, s60
    v_add_u32 v188, s59, v5
    v_bfe_u32 v2, v0, 5, 3
    s_lshl_b32 s64, s49, 3
    v_add_u32 v5, s64, v2
    v_lshlrev_b32 v5, 14, v5
    v_lshl_add_u32 v24, v4, 4, v5
    v_lshlrev_b32 v13, 3, v2
    s_lshl_b32 s64, s48, 10
    buffer_load_dwordx4 v[16:19], v24, s[4:7], s64 offen
    buffer_load_dwordx4 v[20:23], v24, s[4:7], s64 offen offset:512
    s_cmp_lg_u32 s50, 4
    s_cbranch_scc1 L_wt1
    buffer_load_dword v189, v188, s[12:15], 0 offen offset:0
L_wt1:
    s_cmp_lg_u32 s50, 5
    s_cbranch_scc1 L_wt2
    buffer_load_dword v189, v188, s[16:19], 0 offen offset:0
L_wt2:
    s_add_u32 m0, s57, 32768
    s_mov_b32 s53, 229376
    buffer_load_dwordx4 v164, s[12:15], s53 offen lds
    s_add_u32 m0, s57, 40960
    s_nop 0
    buffer_load_dwordx4 v164, s[16:19], s53 offen lds
    s_add_u32 m0, s57, 36864
    s_mov_b32 s53, 344064
    buffer_load_dwordx4 v164, s[12:15], s53 offen lds
    s_add_u32 m0, s57, 45056
    s_nop 0
    buffer_load_dwordx4 v164, s[16:19], s53 offen lds
    s_add_u32 m0, s57, 49152
    s_movk_i32 s56, 128
    buffer_load_dwordx4 v160, s[4:7], s56 offen lds
    s_add_u32 m0, s57, 53248
    s_nop 0
    buffer_load_dwordx4 v161, s[4:7], s56 offen lds
    s_add_u32 m0, s57, 57344
    s_nop 0
    buffer_load_dwordx4 v162, s[4:7], s56 offen lds
    s_add_u32 m0, s57, 61440
    s_nop 0
    buffer_load_dwordx4 v163, s[4:7], s56 offen lds
    v_mov_b32 v166, 0
    s_waitcnt vmcnt(10)
    s_barrier
    s_add_u32 m0, s57, 65536
    s_mov_b32 s53, 458752
    buffer_load_dwordx4 v164, s[12:15], s53 offen lds
    s_mov_b32 s20, s30
    s_mov_b32 s21, s31
    s_mov_b32 s22, 12582912
    s_add_u32 m0, s57, 73728
    s_nop 0
    buffer_load_dwordx4 v164, s[16:19], s53 offen lds
    s_mov_b32 s23, 0x20000
    s_mov_b32 s66, 0xffff0000
    s_lshl_b32 s72, s48, 4
    s_add_u32 s72, s72, s49
    s_add_u32 m0, s57, 69632
    s_mov_b32 s53, 573440
    buffer_load_dwordx4 v164, s[12:15], s53 offen lds
    s_lshl_b32 s72, s72, 7
    s_add_u32 s72, s72, 9510912
    s_bfe_u32 s69, s2, 0x30003
    s_and_b32 s68, s2, 7
    s_add_u32 m0, s57, 77824
    s_nop 0
    buffer_load_dwordx4 v164, s[16:19], s53 offen lds
    s_lshl_b32 s68, s68, 2
    s_lshr_b32 s65, s2, 6
    s_add_u32 s68, s68, s65
    s_lshr_b32 s70, s68, 1
    s_add_u32 m0, s57, 81920
    s_movk_i32 s56, 256
    buffer_load_dwordx4 v160, s[4:7], s56 offen lds
    s_mul_i32 s64, s69, 7
    s_add_u32 s64, s64, s50
    s_lshl_b32 s51, s64, 15
    s_add_u32 m0, s57, 86016
    s_nop 0
    buffer_load_dwordx4 v161, s[4:7], s56 offen lds
    s_add_u32 s51, s51, 10485760
    s_lshl_b32 s64, s64, 9
    s_add_u32 s64, s64, 9629696
    v_and_b32 v4, 3, v1
    s_add_u32 m0, s57, 90112
    s_nop 0
    buffer_load_dwordx4 v162, s[4:7], s56 offen lds
    v_lshlrev_b32 v4, 7, v4
    v_add_u32 v174, s64, v4
    s_mul_i32 s64, s70, 3584
    s_lshl_b32 s65, s50, 9
    s_add_u32 m0, s57, 94208
    s_nop 0
    buffer_load_dwordx4 v163, s[4:7], s56 offen lds
    s_add_u32 s64, s64, s65
    s_add_u32 s64, s64, 9572352
    s_add_u32 s36, s30, s64
    s_addc_u32 s37, s31, 0
    v_lshlrev_b32 v6, 4, v1
    s_waitcnt vmcnt(8)
    s_barrier
    global_load_dwordx2 v[14:15], v166, s[24:25] sc1
    s_add_u32 m0, s57, 98304
    s_mov_b32 s53, 688128
    buffer_load_dwordx4 v164, s[12:15], s53 offen lds
    s_add_u32 m0, s57, 106496
    s_nop 0
    buffer_load_dwordx4 v164, s[16:19], s53 offen lds
    s_add_u32 m0, s57, 102400
    s_mov_b32 s53, 802816
    buffer_load_dwordx4 v164, s[12:15], s53 offen lds
    s_add_u32 m0, s57, 110592
    s_nop 0
    buffer_load_dwordx4 v164, s[16:19], s53 offen lds
    s_add_u32 m0, s57, 114688
    s_movk_i32 s56, 384
    buffer_load_dwordx4 v160, s[4:7], s56 offen lds
    s_add_u32 m0, s57, 118784
    s_nop 0
    buffer_load_dwordx4 v161, s[4:7], s56 offen lds
    s_add_u32 m0, s57, 122880
    s_nop 0
    buffer_load_dwordx4 v162, s[4:7], s56 offen lds
    s_add_u32 m0, s57, 126976
    s_nop 0
    buffer_load_dwordx4 v163, s[4:7], s56 offen lds
    s_add_u32 m0, s57, 131072
    s_mov_b32 s53, 917504
    buffer_load_dwordx4 v164, s[12:15], s53 offen lds
    s_add_u32 m0, s57, 139264
    s_nop 0
    buffer_load_dwordx4 v164, s[16:19], s53 offen lds
    s_add_u32 m0, s57, 135168
    s_mov_b32 s53, 1032192
    buffer_load_dwordx4 v164, s[12:15], s53 offen lds
    s_add_u32 m0, s57, 143360
    s_nop 0
    buffer_load_dwordx4 v164, s[16:19], s53 offen lds
    s_cmp_lg_u32 s50, 7
    s_cbranch_scc1 L_tw3
    s_and_b32 s64, s68, 1
    s_lshl_b32 s64, s64, 9
    s_add_u32 s64, s64, s70
    v_and_b32 v8, 31, v1
    v_lshlrev_b32 v8, 4, v8
    v_add_u32 v8, s64, v8
    v_cvt_f32_u32 v8, v8
    s_mov_b32 s64, 0x3a000000
    s_cmp_ge_u32 s69, 4
    s_cselect_b32 s64, s64, 0xba000000
    v_mul_f32 v8, s64, v8
    v_lshrrev_b32 v9, 5, v1
    v_lshlrev_b32 v9, 3, v9
    v_cvt_f32_u32 v9, v9
    v_mul_f32 v9, v9, v8
L_tw3:
    s_waitcnt vmcnt(13)
    s_barrier
    s_mov_b32 m0, s57
    s_movk_i32 s56, 512
    buffer_load_dwordx4 v160, s[4:7], s56 offen lds
    s_add_u32 m0, s57, 4096
    s_nop 0
    buffer_load_dwordx4 v161, s[4:7], s56 offen lds
    s_add_u32 m0, s57, 8192
    s_nop 0
    buffer_load_dwordx4 v162, s[4:7], s56 offen lds
    s_add_u32 m0, s57, 12288
    s_nop 0
    buffer_load_dwordx4 v163, s[4:7], s56 offen lds
    s_add_u32 m0, s57, 16384
    s_mov_b32 s53, 1146880
    buffer_load_dwordx4 v164, s[12:15], s53 offen lds
    s_add_u32 m0, s57, 24576
    s_nop 0
    buffer_load_dwordx4 v164, s[16:19], s53 offen lds
    s_add_u32 m0, s57, 20480
    s_mov_b32 s53, 1261568
    buffer_load_dwordx4 v164, s[12:15], s53 offen lds
    s_add_u32 m0, s57, 28672
    s_nop 0
    buffer_load_dwordx4 v164, s[16:19], s53 offen lds
    s_add_u32 m0, s57, 32768
    s_movk_i32 s56, 640
    buffer_load_dwordx4 v160, s[4:7], s56 offen lds
    s_add_u32 m0, s57, 36864
    s_nop 0
    buffer_load_dwordx4 v161, s[4:7], s56 offen lds
    s_add_u32 m0, s57, 40960
    s_nop 0
    buffer_load_dwordx4 v162, s[4:7], s56 offen lds
    s_add_u32 m0, s57, 45056
    s_nop 0
    buffer_load_dwordx4 v163, s[4:7], s56 offen lds
    s_waitcnt vmcnt(16)
    s_barrier
    s_cmp_lg_u32 s50, 6
    s_cbranch_scc1 L_wt4
    buffer_load_dword v189, v188, s[12:15], 0 offen offset:128
L_wt4:
    s_cmp_lg_u32 s50, 7
    s_cbranch_scc1 L_wt5
    buffer_load_dword v189, v188, s[16:19], 0 offen offset:128
L_wt5:
    s_waitcnt vmcnt(41)
    s_add_u32 m0, s57, 49152
    s_mov_b32 s53, 1376256
    buffer_load_dwordx4 v164, s[12:15], s53 offen lds
    v_lshlrev_b32 v24, 16, v16
    v_and_b32 v25, s66, v16
    v_lshlrev_b32 v26, 16, v17
    v_and_b32 v27, s66, v17
    v_lshlrev_b32 v28, 16, v18
    v_and_b32 v29, s66, v18
    v_lshlrev_b32 v30, 16, v19
    v_and_b32 v31, s66, v19
    v_lshlrev_b32 v32, 16, v20
    s_add_u32 m0, s57, 57344
    s_nop 0
    buffer_load_dwordx4 v164, s[16:19], s53 offen lds
    v_and_b32 v33, s66, v20
    v_lshlrev_b32 v34, 16, v21
    v_and_b32 v35, s66, v21
    v_lshlrev_b32 v36, 16, v22
    v_and_b32 v37, s66, v22
    v_lshlrev_b32 v38, 16, v23
    v_and_b32 v39, s66, v23
    v_add_f32 v40, v24, v26
    v_mul_f32 v41, v24, v24
    v_add_f32 v42, v25, v27
    s_add_u32 m0, s57, 53248
    s_mov_b32 s53, 1490944
    buffer_load_dwordx4 v164, s[12:15], s53 offen lds
    v_mul_f32 v43, v25, v25
    v_add_f32 v40, v40, v28
    v_add_f32 v42, v42, v29
    v_add_f32 v40, v40, v30
    v_add_f32 v42, v42, v31
    v_add_f32 v40, v40, v32
    v_add_f32 v42, v42, v33
    v_add_f32 v40, v40, v34
    v_add_f32 v42, v42, v35
    v_add_f32 v40, v40, v36
    s_add_u32 m0, s57, 61440
    s_nop 0
    buffer_load_dwordx4 v164, s[16:19], s53 offen lds
    v_add_f32 v42, v42, v37
    v_add_f32 v40, v40, v38
    v_add_f32 v42, v42, v39
    v_fmac_f32 v41, v26, v26
    v_fmac_f32 v43, v27, v27
    v_fmac_f32 v41, v28, v28
    v_fmac_f32 v43, v29, v29
    v_fmac_f32 v41, v30, v30
    v_fmac_f32 v43, v31, v31
    v_fmac_f32 v41, v32, v32
    s_add_u32 m0, s57, 65536
    s_movk_i32 s56, 768
    buffer_load_dwordx4 v160, s[4:7], s56 offen lds
    v_fmac_f32 v43, v33, v33
    v_fmac_f32 v41, v34, v34
    v_fmac_f32 v43, v35, v35
    v_fmac_f32 v41, v36, v36
    v_fmac_f32 v43, v37, v37
    v_fmac_f32 v41, v38, v38
    v_fmac_f32 v43, v39, v39
    v_add_f32 v40, v40, v42
    v_add_f32 v41, v41, v43
    s_nop 0
    s_add_u32 m0, s57, 69632
    s_nop 0
    buffer_load_dwordx4 v161, s[4:7], s56 offen lds
    v_add_f32_dpp v40, v40, v40 row_shr:1 row_mask:0xf bank_mask:0xf bound_ctrl:0
    v_add_f32_dpp v41, v41, v41 row_shr:1 row_mask:0xf bank_mask:0xf bound_ctrl:0
    s_nop 0
    v_add_f32_dpp v40, v40, v40 row_shr:2 row_mask:0xf bank_mask:0xf bound_ctrl:0
    v_add_f32_dpp v41, v41, v41 row_shr:2 row_mask:0xf bank_mask:0xf bound_ctrl:0
    s_nop 0
    v_add_f32_dpp v40, v40, v40 row_shr:4 row_mask:0xf bank_mask:0xf bound_ctrl:0
    v_add_f32_dpp v41, v41, v41 row_shr:4 row_mask:0xf bank_mask:0xf bound_ctrl:0
    s_nop 0
    v_add_f32_dpp v40, v40, v40 row_shr:8 row_mask:0xf bank_mask:0xf bound_ctrl:0
    s_add_u32 m0, s57, 73728
    s_nop 0
    buffer_load_dwordx4 v162, s[4:7], s56 offen lds
    v_add_f32_dpp v41, v41, v41 row_shr:8 row_mask:0xf bank_mask:0xf bound_ctrl:0
    s_nop 0
    v_add_f32_dpp v40, v40, v40 row_bcast:15 row_mask:0xa bank_mask:0xf
    v_add_f32_dpp v41, v41, v41 row_bcast:15 row_mask:0xa bank_mask:0xf
    v_mul_f32 v42, 0x3b000000, v40
    v_mul_f32 v43, 0x3b000000, v41
    v_fma_f32 v43, -v42, v42, v43
    v_max_f32 v43, 0, v43
    v_cvt_pk_bf16_f32 v44, v42, v43
    v_lshlrev_b32 v42, 16, v44
    s_add_u32 m0, s57, 77824
    s_nop 0
    buffer_load_dwordx4 v163, s[4:7], s56 offen lds
    v_and_b32 v43, s66, v44
    v_add_f32 v43, 0x3727c5ac, v43
    v_cvt_pk_bf16_f32 v44, v43, v43
    v_and_b32 v43, s66, v44
    v_sqrt_f32 v43, v43
    s_nop 0
    v_cvt_pk_bf16_f32 v44, v43, v43
    v_and_b32 v43, s66, v44
    v_lshrrev_b32 v42, 16, v42
    v_or_b32 v146, v42, v43
    s_waitcnt vmcnt(32)
    v_readfirstlane_b32 s61, v14
    s_cmp_eq_u32 s61, 0
    s_cbranch_scc1 L_ns7
L_nb6:
    v_readfirstlane_b32 s34, v14
    v_readfirstlane_b32 s35, v15
    v_mov_b32 v147, v14
    s_mov_b32 exec_lo, 0x80000000
    s_mov_b32 exec_hi, 0x80000000
    buffer_store_dwordx2 v[146:147], v13, s[20:23], s72 offen sc1
    s_mov_b64 exec, -1
    s_cmp_lg_u32 s50, 7
    s_cbranch_scc1 L_tw9
    v_fmamk_f32 v48, v8, 0x00000000, v9
    v_fmamk_f32 v49, v8, 0x40000000, v9
    v_fmamk_f32 v50, v8, 0x40800000, v9
    v_fmamk_f32 v51, v8, 0x40c00000, v9
    v_cos_f32 v52, v48
    v_cos_f32 v53, v49
    v_cos_f32 v54, v50
    v_cos_f32 v55, v51
    v_sin_f32 v56, v48
    v_sin_f32 v57, v49
    v_sin_f32 v58, v50
    v_sin_f32 v59, v51
    v_cvt_pk_bf16_f32 v192, v52, v53
    v_cvt_pk_bf16_f32 v193, v54, v55
    v_cvt_pk_bf16_f32 v194, v56, v57
    v_cvt_pk_bf16_f32 v195, v58, v59
L_tw9:
    s_waitcnt vmcnt(17)
    s_barrier
    s_add_u32 m0, s57, 98304
    s_mov_b32 s53, 1605632
    buffer_load_dwordx4 v164, s[12:15], s53 offen lds
    s_bfe_u32 s71, s50, 0x10001
    s_and_b32 s63, s50, 1
    v_lshrrev_b32 v2, 5, v1
    v_and_b32 v3, 31, v1
    v_bfe_u32 v5, v1, 3, 1
    v_xor_b32 v5, s63, v5
    v_lshlrev_b32 v5, 6, v5
    s_add_u32 m0, s57, 106496
    s_nop 0
    buffer_load_dwordx4 v164, s[16:19], s53 offen lds
    v_lshl_add_u32 v5, v2, 10, v5
    v_bfe_u32 v4, v1, 2, 2
    v_lshl_add_u32 v5, v4, 7, v5
    v_and_b32 v4, 3, v1
    v_lshl_add_u32 v5, v4, 3, v5
    v_bfe_u32 v4, v1, 4, 1
    v_lshl_add_u32 v5, v4, 5, v5
    s_lshl_b32 s65, s71, 12
    s_add_u32 m0, s57, 102400
    s_mov_b32 s53, 1720320
    buffer_load_dwordx4 v164, s[12:15], s53 offen lds
    v_add_u32 v140, s65, v5
    v_xor_b32 v141, 4096, v140
    v_and_b32 v5, 15, v1
    v_lshlrev_b32 v4, 2, v4
    v_sub_u32 v5, v5, v4
    v_cmp_eq_u32 s[78:79], 0, v5
    v_cmp_eq_u32 s[76:77], 8, v5
    s_add_u32 m0, s57, 110592
    s_nop 0
    buffer_load_dwordx4 v164, s[16:19], s53 offen lds
    v_mov_b32 v5, 0x3f803f80
    v_bfe_u32 v4, v1, 1, 3
    v_cndmask_b32 v148, 0, v5, s[78:79]
    v_cndmask_b32 v152, 0, v5, s[76:77]
    v_cndmask_b32 v149, 0, v5, s[78:79]
    v_cndmask_b32 v153, 0, v5, s[76:77]
    v_cndmask_b32 v150, 0, v5, s[78:79]
    v_cndmask_b32 v154, 0, v5, s[76:77]
    s_cmp_lg_u32 s50, 7
    s_cbranch_scc1 L_tw10
    v_fmamk_f32 v60, v8, 0x3f800000, v9
    v_fmamk_f32 v61, v8, 0x40400000, v9
    v_fmamk_f32 v62, v8, 0x40a00000, v9
    v_fmamk_f32 v63, v8, 0x40e00000, v9
    v_cos_f32 v64, v60
    v_cos_f32 v65, v61
    v_cos_f32 v66, v62
    v_cos_f32 v67, v63
    v_sin_f32 v68, v60
    v_sin_f32 v69, v61
    v_sin_f32 v70, v62
    v_sin_f32 v71, v63
    v_cvt_pk_bf16_f32 v196, v64, v65
    v_cvt_pk_bf16_f32 v197, v66, v67
    v_cvt_pk_bf16_f32 v198, v68, v69
    v_cvt_pk_bf16_f32 v199, v70, v71
L_tw10:
    s_waitcnt vmcnt(13)
    s_barrier
    s_add_u32 m0, s57, 131072
    s_movk_i32 s56, 896
    buffer_load_dwordx4 v160, s[4:7], s56 offen lds
    v_cndmask_b32 v151, 0, v5, s[78:79]
    v_cndmask_b32 v155, 0, v5, s[76:77]
    v_xor_b32 v4, v4, v2
    v_lshlrev_b32 v4, 4, v4
    v_lshl_add_u32 v4, v3, 7, v4
    s_mul_i32 s64, s71, 8256
    v_xor_b32 v4, s64, v4
    s_add_u32 m0, s57, 135168
    s_nop 0
    buffer_load_dwordx4 v161, s[4:7], s56 offen lds
    v_xor_b32 v128, 0, v4
    v_xor_b32 v129, 32, v4
    v_xor_b32 v130, 64, v4
    v_xor_b32 v131, 96, v4
    v_add_u32 v132, 49152, v128
    v_add_u32 v133, 49152, v129
    v_add_u32 v134, 49152, v130
    v_add_u32 v135, 49152, v131
    s_add_u32 m0, s57, 139264
    s_nop 0
    buffer_load_dwordx4 v162, s[4:7], s56 offen lds
    v_add_u32 v142, 49152, v140
    v_add_u32 v143, 49152, v141
    v_add_u32 v136, 98304, v128
    v_add_u32 v137, 98304, v129
    v_add_u32 v138, 98304, v130
    v_add_u32 v139, 98304, v131
    v_add_u32 v144, 98304, v140
    s_add_u32 m0, s57, 143360
    s_nop 0
    buffer_load_dwordx4 v163, s[4:7], s56 offen lds
    v_add_u32 v145, 98304, v141
    s_mul_i32 s55, s48, 28
    s_mul_i32 s64, s62, 14
    s_add_u32 s55, s55, s64
    s_add_u32 s55, s55, s49
    s_lshl_b32 s55, s55, 7
    s_add_u32 s55, s55, 9572352
    s_lshl_b32 s64, s48, 11
    s_cmp_lg_u32 s50, 7
    s_cbranch_scc1 L_tw11
    v_fmamk_f32 v48, v8, 0x41800000, v9
    v_fmamk_f32 v49, v8, 0x41900000, v9
    v_fmamk_f32 v50, v8, 0x41a00000, v9
    v_fmamk_f32 v51, v8, 0x41b00000, v9
    v_cos_f32 v52, v48
    v_cos_f32 v53, v49
    v_cos_f32 v54, v50
    v_cos_f32 v55, v51
    v_sin_f32 v56, v48
    v_sin_f32 v57, v49
    v_sin_f32 v58, v50
    v_sin_f32 v59, v51
    v_cvt_pk_bf16_f32 v200, v52, v53
    v_cvt_pk_bf16_f32 v201, v54, v55
    v_cvt_pk_bf16_f32 v202, v56, v57
    v_cvt_pk_bf16_f32 v203, v58, v59
L_tw11:
    s_waitcnt vmcnt(9)
    s_barrier
    s_add_u32 m0, s57, 16384
    s_mov_b32 s53, 458880
    buffer_load_dwordx4 v164, s[12:15], s53 offen lds
    s_lshl_b32 s65, s71, 10
    s_add_u32 s64, s64, s65
    s_add_u32 s64, s64, 9510912
    v_and_b32 v4, 7, v1
    v_lshlrev_b32 v4, 3, v4
    v_lshrrev_b32 v5, 3, v1
    v_lshl_add_u32 v4, v5, 7, v4
    s_add_u32 m0, s57, 24576
    s_nop 0
    buffer_load_dwordx4 v164, s[16:19], s53 offen lds
    v_add_u32 v171, s64, v4
    v_lshlrev_b32 v4, 2, v0
    v_add_u32 v168, 151552, v4
    s_and_b32 s64, s50, 5
    s_lshl_b32 s64, s64, 8
    s_add_u32 s64, s64, 151552
    v_lshlrev_b32 v4, 2, v3
    v_lshl_add_u32 v4, v2, 9, v4
    s_add_u32 m0, s57, 20480
    s_mov_b32 s53, 573568
    buffer_load_dwordx4 v164, s[12:15], s53 offen lds
    v_add_u32 v169, s64, v4
    s_lshl_b32 s64, s48, 2
    s_lshl_b32 s65, s71, 1
    s_add_u32 s64, s64, s65
    s_mul_i32 s74, s64, 114688
    s_lshl_b32 s64, s49, 13
    s_lshl_b32 s65, s62, 12
    s_add_u32 s64, s64, s65
    s_add_u32 m0, s57, 28672
    s_nop 0
    buffer_load_dwordx4 v164, s[16:19], s53 offen lds
    s_lshl_b32 s65, s63, 11
    s_add_u32 s64, s64, s65
    s_add_u32 s74, s74, s64
    s_add_u32 s75, s74, 114688
    v_mov_b32 v183, 0
    v_mov_b32 v185, 0
    v_mov_b32 v186, 0
    v_mov_b32 v187, 0
    s_cmp_lg_u32 s50, 7
    s_cbranch_scc1 L_tw12
    v_fmamk_f32 v60, v8, 0x41880000, v9
    v_fmamk_f32 v61, v8, 0x41980000, v9
    v_fmamk_f32 v62, v8, 0x41a80000, v9
    v_fmamk_f32 v63, v8, 0x41b80000, v9
    v_cos_f32 v64, v60
    v_cos_f32 v65, v61
    v_cos_f32 v66, v62
    v_cos_f32 v67, v63
    v_sin_f32 v68, v60
    v_sin_f32 v69, v61
    v_sin_f32 v70, v62
    v_sin_f32 v71, v63
    v_cvt_pk_bf16_f32 v204, v64, v65
    v_cvt_pk_bf16_f32 v205, v66, v67
    v_cvt_pk_bf16_f32 v206, v68, v69
    v_cvt_pk_bf16_f32 v207, v70, v71
L_tw12:
    buffer_load_dwordx2 v[146:147], v171, s[20:23], 0 offen sc1
    s_waitcnt vmcnt(5)
    s_barrier
    s_add_u32 m0, s57, 49152
    s_mov_b32 s53, 688256
    buffer_load_dwordx4 v164, s[12:15], s53 offen lds
    s_add_u32 m0, s57, 57344
    s_nop 0
    buffer_load_dwordx4 v164, s[16:19], s53 offen lds
    s_add_u32 m0, s57, 53248
    s_mov_b32 s53, 802944
    buffer_load_dwordx4 v164, s[12:15], s53 offen lds
    s_add_u32 m0, s57, 61440
    s_nop 0
    buffer_load_dwordx4 v164, s[16:19], s53 offen lds
    s_waitcnt vmcnt(4)
    v_cmp_ne_u32 s[78:79], v147, v14
    s_cmp_lg_u64 s[78:79], 0
    s_cbranch_scc1 L_ts14
L_tb13:
    v_and_b32 v182, 0xffff, v146
    v_and_b32 v4, s66, v146
    v_xor_b32 v182, 0x8000, v182
    v_rcp_f32 v5, v4
    v_lshl_or_b32 v182, v182, 16, v182
    v_mul_f32 v176, v4, v4
    v_mul_f32 v178, 0xc0135761, v5
    v_mul_f32 v4, v5, v5
    v_mul_f32 v4, v4, v5
    v_mul_f32 v180, 0xbdd2d3e8, v4
    v_mov_b32 v184, v182
    v_mov_b32 v177, v176
    v_mov_b32 v179, v178
    v_mov_b32 v181, v180
    s_nop 1
    v_permlane32_swap_b32 v182, v184
    v_permlane32_swap_b32 v176, v177
    v_permlane32_swap_b32 v178, v179
    v_permlane32_swap_b32 v180, v181
    s_setprio 2
    s_waitcnt vmcnt(5)
    s_barrier
    ds_read_b128 v[112:115], v132 offset:32768
    ds_read_b64_tr_b16 v[120:121], v140 offset:16384
    ds_read_b64_tr_b16 v[122:123], v140 offset:16896
    ds_read_b64_tr_b16 v[124:125], v140 offset:24576
    ds_read_b64_tr_b16 v[126:127], v140 offset:25088
    ds_read_b128 v[116:119], v132 offset:36864
    ds_read_b128 v[80:83], v133 offset:32768
    ds_read_b64_tr_b16 v[88:89], v140 offset:18432
    ds_read_b64_tr_b16 v[90:91], v140 offset:18944
    ds_read_b64_tr_b16 v[92:93], v140 offset:26624
    ds_read_b64_tr_b16 v[94:95], v140 offset:27136
    ds_read_b128 v[84:87], v133 offset:36864
    s_waitcnt lgkmcnt(6)
    v_mfma_f32_32x32x16_bf16 v[16:31], v[120:123], v[112:115], 0
    ds_read_b128 v[96:99], v134 offset:32768
    ds_read_b64_tr_b16 v[104:105], v141 offset:16384
    v_mfma_f32_32x32x16_bf16 v[32:47], v[124:127], v[112:115], 0
    ds_read_b64_tr_b16 v[106:107], v141 offset:16896
    ds_read_b64_tr_b16 v[108:109], v141 offset:24576
    v_mfma_f32_32x32x16_bf16 v[48:63], v[120:123], v[116:119], 0
    ds_read_b64_tr_b16 v[110:111], v141 offset:25088
    ds_read_b128 v[100:103], v134 offset:36864
    v_mfma_f32_16x16x32_bf16 v[156:159], v[148:151], v[120:123], 0
    v_mfma_f32_32x32x16_bf16 v[64:79], v[124:127], v[116:119], 0
    v_mfma_f32_16x16x32_bf16 v[156:159], v[152:155], v[124:127], v[156:159]
    s_waitcnt lgkmcnt(6)
    v_mfma_f32_32x32x16_bf16 v[16:31], v[88:91], v[80:83], v[16:31]
    ds_read_b128 v[112:115], v135 offset:32768
    ds_read_b64_tr_b16 v[120:121], v141 offset:18432
    v_mfma_f32_32x32x16_bf16 v[32:47], v[92:95], v[80:83], v[32:47]
    ds_read_b64_tr_b16 v[122:123], v141 offset:18944
    ds_read_b64_tr_b16 v[124:125], v141 offset:26624
    v_mfma_f32_32x32x16_bf16 v[48:63], v[88:91], v[84:87], v[48:63]
    ds_read_b64_tr_b16 v[126:127], v141 offset:27136
    ds_read_b128 v[116:119], v135 offset:36864
    v_mfma_f32_16x16x32_bf16 v[156:159], v[148:151], v[88:91], v[156:159]
    v_mfma_f32_32x32x16_bf16 v[64:79], v[92:95], v[84:87], v[64:79]
    v_mfma_f32_16x16x32_bf16 v[156:159], v[152:155], v[92:95], v[156:159]
    s_waitcnt lgkmcnt(6)
    v_mfma_f32_32x32x16_bf16 v[16:31], v[104:107], v[96:99], v[16:31]
    s_waitcnt vmcnt(0) lgkmcnt(0)
    s_barrier
    ds_read_b128 v[80:83], v136 offset:16384
    ds_read_b64_tr_b16 v[88:89], v142 offset:0
    v_mfma_f32_32x32x16_bf16 v[32:47], v[108:111], v[96:99], v[32:47]
    ds_read_b64_tr_b16 v[90:91], v142 offset:512
    ds_read_b64_tr_b16 v[92:93], v142 offset:8192
    v_mfma_f32_32x32x16_bf16 v[48:63], v[104:107], v[100:103], v[48:63]
    ds_read_b64_tr_b16 v[94:95], v142 offset:8704
    ds_read_b128 v[84:87], v136 offset:20480
    v_mfma_f32_32x32x16_bf16 v[64:79], v[108:111], v[100:103], v[64:79]
    v_mfma_f32_32x32x16_bf16 v[16:31], v[120:123], v[112:115], v[16:31]
    ds_read_b128 v[96:99], v137 offset:16384
    ds_read_b64_tr_b16 v[104:105], v142 offset:2048
    v_mfma_f32_32x32x16_bf16 v[32:47], v[124:127], v[112:115], v[32:47]
    ds_read_b64_tr_b16 v[106:107], v142 offset:2560
    ds_read_b64_tr_b16 v[108:109], v142 offset:10240
    v_mfma_f32_32x32x16_bf16 v[48:63], v[120:123], v[116:119], v[48:63]
    ds_read_b64_tr_b16 v[110:111], v142 offset:10752
    ds_read_b128 v[100:103], v137 offset:20480
    v_mfma_f32_32x32x16_bf16 v[64:79], v[124:127], v[116:119], v[64:79]
    s_waitcnt lgkmcnt(6)
    v_mfma_f32_32x32x16_bf16 v[16:31], v[88:91], v[80:83], v[16:31]
    ds_read_b128 v[112:115], v138 offset:16384
    ds_read_b64_tr_b16 v[120:121], v143 offset:0
    v_mfma_f32_32x32x16_bf16 v[32:47], v[92:95], v[80:83], v[32:47]
    ds_read_b64_tr_b16 v[122:123], v143 offset:512
    ds_read_b64_tr_b16 v[124:125], v143 offset:8192
    v_mfma_f32_32x32x16_bf16 v[48:63], v[88:91], v[84:87], v[48:63]
    ds_read_b64_tr_b16 v[126:127], v143 offset:8704
    ds_read_b128 v[116:119], v138 offset:20480
    v_mfma_f32_16x16x32_bf16 v[156:159], v[148:151], v[88:91], v[156:159]
    v_mfma_f32_32x32x16_bf16 v[64:79], v[92:95], v[84:87], v[64:79]
    v_mfma_f32_16x16x32_bf16 v[156:159], v[152:155], v[92:95], v[156:159]
    s_waitcnt lgkmcnt(6)
    v_mfma_f32_32x32x16_bf16 v[16:31], v[104:107], v[96:99], v[16:31]
    ds_read_b128 v[80:83], v139 offset:16384
    ds_read_b64_tr_b16 v[88:89], v143 offset:2048
    v_mfma_f32_32x32x16_bf16 v[32:47], v[108:111], v[96:99], v[32:47]
    ds_read_b64_tr_b16 v[90:91], v143 offset:2560
    ds_read_b64_tr_b16 v[92:93], v143 offset:10240
    v_mfma_f32_32x32x16_bf16 v[48:63], v[104:107], v[100:103], v[48:63]
    ds_read_b64_tr_b16 v[94:95], v143 offset:10752
    ds_read_b128 v[84:87], v139 offset:20480
    v_mfma_f32_16x16x32_bf16 v[156:159], v[148:151], v[104:107], v[156:159]
    v_mfma_f32_32x32x16_bf16 v[64:79], v[108:111], v[100:103], v[64:79]
    v_mfma_f32_16x16x32_bf16 v[156:159], v[152:155], v[108:111], v[156:159]
    s_waitcnt lgkmcnt(6)
    v_mfma_f32_32x32x16_bf16 v[16:31], v[120:123], v[112:115], v[16:31]
    s_waitcnt lgkmcnt(0)
    s_barrier
    ds_read_b128 v[96:99], v128 offset:0
    ds_read_b64_tr_b16 v[104:105], v144 offset:0
    v_mfma_f32_32x32x16_bf16 v[32:47], v[124:127], v[112:115], v[32:47]
    ds_read_b64_tr_b16 v[106:107], v144 offset:512
    ds_read_b64_tr_b16 v[108:109], v144 offset:8192
    v_mfma_f32_32x32x16_bf16 v[48:63], v[120:123], v[116:119], v[48:63]
    ds_read_b64_tr_b16 v[110:111], v144 offset:8704
    ds_read_b128 v[100:103], v128 offset:4096
    v_mfma_f32_32x32x16_bf16 v[64:79], v[124:127], v[116:119], v[64:79]
    v_mfma_f32_32x32x16_bf16 v[16:31], v[88:91], v[80:83], v[16:31]
    ds_read_b128 v[112:115], v129 offset:0
    ds_read_b64_tr_b16 v[120:121], v144 offset:2048
    v_mfma_f32_32x32x16_bf16 v[32:47], v[92:95], v[80:83], v[32:47]
    ds_read_b64_tr_b16 v[122:123], v144 offset:2560
    ds_read_b64_tr_b16 v[124:125], v144 offset:10240
    v_mfma_f32_32x32x16_bf16 v[48:63], v[88:91], v[84:87], v[48:63]
    ds_read_b64_tr_b16 v[126:127], v144 offset:10752
    ds_read_b128 v[116:119], v129 offset:4096
    v_mfma_f32_32x32x16_bf16 v[64:79], v[92:95], v[84:87], v[64:79]
    s_waitcnt lgkmcnt(6)
    v_mfma_f32_32x32x16_bf16 v[16:31], v[104:107], v[96:99], v[16:31]
    ds_read_b128 v[80:83], v130 offset:0
    ds_read_b64_tr_b16 v[88:89], v145 offset:0
    v_mfma_f32_32x32x16_bf16 v[32:47], v[108:111], v[96:99], v[32:47]
    ds_read_b64_tr_b16 v[90:91], v145 offset:512
    ds_read_b64_tr_b16 v[92:93], v145 offset:8192
    v_mfma_f32_32x32x16_bf16 v[48:63], v[104:107], v[100:103], v[48:63]
    ds_read_b64_tr_b16 v[94:95], v145 offset:8704
    ds_read_b128 v[84:87], v130 offset:4096
    v_mfma_f32_16x16x32_bf16 v[156:159], v[148:151], v[104:107], v[156:159]
    v_mfma_f32_32x32x16_bf16 v[64:79], v[108:111], v[100:103], v[64:79]
    v_mfma_f32_16x16x32_bf16 v[156:159], v[152:155], v[108:111], v[156:159]
    s_waitcnt lgkmcnt(6)
    v_mfma_f32_32x32x16_bf16 v[16:31], v[120:123], v[112:115], v[16:31]
    ds_read_b128 v[96:99], v131 offset:0
    ds_read_b64_tr_b16 v[104:105], v145 offset:2048
    v_mfma_f32_32x32x16_bf16 v[32:47], v[124:127], v[112:115], v[32:47]
    ds_read_b64_tr_b16 v[106:107], v145 offset:2560
    ds_read_b64_tr_b16 v[108:109], v145 offset:10240
    v_mfma_f32_32x32x16_bf16 v[48:63], v[120:123], v[116:119], v[48:63]
    ds_read_b64_tr_b16 v[110:111], v145 offset:10752
    ds_read_b128 v[100:103], v131 offset:4096
    v_mfma_f32_16x16x32_bf16 v[156:159], v[148:151], v[120:123], v[156:159]
    v_mfma_f32_32x32x16_bf16 v[64:79], v[124:127], v[116:119], v[64:79]
    v_mfma_f32_16x16x32_bf16 v[156:159], v[152:155], v[124:127], v[156:159]
    s_waitcnt lgkmcnt(6)
    v_mfma_f32_32x32x16_bf16 v[16:31], v[88:91], v[80:83], v[16:31]
    s_waitcnt lgkmcnt(0)
    s_barrier
    ds_read_b128 v[112:115], v128 offset:32768
    ds_read_b64_tr_b16 v[120:121], v140 offset:16384
    v_mfma_f32_32x32x16_bf16 v[32:47], v[92:95], v[80:83], v[32:47]
    ds_read_b64_tr_b16 v[122:123], v140 offset:16896
    ds_read_b64_tr_b16 v[124:125], v140 offset:24576
    v_mfma_f32_32x32x16_bf16 v[48:63], v[88:91], v[84:87], v[48:63]
    ds_read_b64_tr_b16 v[126:127], v140 offset:25088
    ds_read_b128 v[116:119], v128 offset:36864
    v_mfma_f32_32x32x16_bf16 v[64:79], v[92:95], v[84:87], v[64:79]
    v_mfma_f32_32x32x16_bf16 v[16:31], v[104:107], v[96:99], v[16:31]
    ds_read_b128 v[80:83], v129 offset:32768
    ds_read_b64_tr_b16 v[88:89], v140 offset:18432
    v_mfma_f32_32x32x16_bf16 v[32:47], v[108:111], v[96:99], v[32:47]
    ds_read_b64_tr_b16 v[90:91], v140 offset:18944
    ds_read_b64_tr_b16 v[92:93], v140 offset:26624
    v_mfma_f32_32x32x16_bf16 v[48:63], v[104:107], v[100:103], v[48:63]
    ds_read_b64_tr_b16 v[94:95], v140 offset:27136
    ds_read_b128 v[84:87], v129 offset:36864
    v_mfma_f32_32x32x16_bf16 v[64:79], v[108:111], v[100:103], v[64:79]
    s_waitcnt lgkmcnt(6)
    v_mfma_f32_32x32x16_bf16 v[16:31], v[120:123], v[112:115], v[16:31]
    ds_read_b128 v[96:99], v130 offset:32768
    ds_read_b64_tr_b16 v[104:105], v141 offset:16384
    v_mfma_f32_32x32x16_bf16 v[32:47], v[124:127], v[112:115], v[32:47]
    ds_read_b64_tr_b16 v[106:107], v141 offset:16896
    ds_read_b64_tr_b16 v[108:109], v141 offset:24576
    v_mfma_f32_32x32x16_bf16 v[48:63], v[120:123], v[116:119], v[48:63]
    ds_read_b64_tr_b16 v[110:111], v141 offset:25088
    ds_read_b128 v[100:103], v130 offset:36864
    v_mfma_f32_16x16x32_bf16 v[156:159], v[148:151], v[120:123], v[156:159]
    v_mfma_f32_32x32x16_bf16 v[64:79], v[124:127], v[116:119], v[64:79]
    v_mfma_f32_16x16x32_bf16 v[156:159], v[152:155], v[124:127], v[156:159]
    s_waitcnt lgkmcnt(6)
    v_mfma_f32_32x32x16_bf16 v[16:31], v[88:91], v[80:83], v[16:31]
    ds_read_b128 v[112:115], v131 offset:32768
    ds_read_b64_tr_b16 v[120:121], v141 offset:18432
    v_mfma_f32_32x32x16_bf16 v[32:47], v[92:95], v[80:83], v[32:47]
    ds_read_b64_tr_b16 v[122:123], v141 offset:18944
    ds_read_b64_tr_b16 v[124:125], v141 offset:26624
    v_mfma_f32_32x32x16_bf16 v[48:63], v[88:91], v[84:87], v[48:63]
    ds_read_b64_tr_b16 v[126:127], v141 offset:27136
    ds_read_b128 v[116:119], v131 offset:36864
    v_mfma_f32_16x16x32_bf16 v[156:159], v[148:151], v[88:91], v[156:159]
    v_mfma_f32_32x32x16_bf16 v[64:79], v[92:95], v[84:87], v[64:79]
    v_mfma_f32_16x16x32_bf16 v[156:159], v[152:155], v[92:95], v[156:159]
    s_waitcnt lgkmcnt(6)
    v_mfma_f32_32x32x16_bf16 v[16:31], v[104:107], v[96:99], v[16:31]
    s_waitcnt lgkmcnt(0)
    s_barrier
    ds_read_b128 v[80:83], v132 offset:16384
    ds_read_b64_tr_b16 v[88:89], v142 offset:32768
    v_mfma_f32_32x32x16_bf16 v[32:47], v[108:111], v[96:99], v[32:47]
    ds_read_b64_tr_b16 v[90:91], v142 offset:33280
    ds_read_b64_tr_b16 v[92:93], v142 offset:40960
    v_mfma_f32_32x32x16_bf16 v[48:63], v[104:107], v[100:103], v[48:63]
    ds_read_b64_tr_b16 v[94:95], v142 offset:41472
    ds_read_b128 v[84:87], v132 offset:20480
    v_mfma_f32_32x32x16_bf16 v[64:79], v[108:111], v[100:103], v[64:79]
    v_mfma_f32_32x32x16_bf16 v[16:31], v[120:123], v[112:115], v[16:31]
    ds_read_b128 v[96:99], v133 offset:16384
    ds_read_b64_tr_b16 v[104:105], v142 offset:34816
    v_mfma_f32_32x32x16_bf16 v[32:47], v[124:127], v[112:115], v[32:47]
    ds_read_b64_tr_b16 v[106:107], v142 offset:35328
    ds_read_b64_tr_b16 v[108:109], v142 offset:43008
    v_mfma_f32_32x32x16_bf16 v[48:63], v[120:123], v[116:119], v[48:63]
    ds_read_b64_tr_b16 v[110:111], v142 offset:43520
    ds_read_b128 v[100:103], v133 offset:20480
    v_mfma_f32_32x32x16_bf16 v[64:79], v[124:127], v[116:119], v[64:79]
    s_waitcnt lgkmcnt(6)
    v_mfma_f32_32x32x16_bf16 v[16:31], v[88:91], v[80:83], v[16:31]
    ds_read_b128 v[112:115], v134 offset:16384
    ds_read_b64_tr_b16 v[120:121], v143 offset:32768
    v_mfma_f32_32x32x16_bf16 v[32:47], v[92:95], v[80:83], v[32:47]
    ds_read_b64_tr_b16 v[122:123], v143 offset:33280
    ds_read_b64_tr_b16 v[124:125], v143 offset:40960
    v_mfma_f32_32x32x16_bf16 v[48:63], v[88:91], v[84:87], v[48:63]
    ds_read_b64_tr_b16 v[126:127], v143 offset:41472
    ds_read_b128 v[116:119], v134 offset:20480
    v_mfma_f32_16x16x32_bf16 v[156:159], v[148:151], v[88:91], v[156:159]
    v_mfma_f32_32x32x16_bf16 v[64:79], v[92:95], v[84:87], v[64:79]
    v_mfma_f32_16x16x32_bf16 v[156:159], v[152:155], v[92:95], v[156:159]
    s_waitcnt lgkmcnt(6)
    v_mfma_f32_32x32x16_bf16 v[16:31], v[104:107], v[96:99], v[16:31]
    ds_read_b128 v[80:83], v135 offset:16384
    ds_read_b64_tr_b16 v[88:89], v143 offset:34816
    v_mfma_f32_32x32x16_bf16 v[32:47], v[108:111], v[96:99], v[32:47]
    ds_read_b64_tr_b16 v[90:91], v143 offset:35328
    ds_read_b64_tr_b16 v[92:93], v143 offset:43008
    v_mfma_f32_32x32x16_bf16 v[48:63], v[104:107], v[100:103], v[48:63]
    ds_read_b64_tr_b16 v[94:95], v143 offset:43520
    ds_read_b128 v[84:87], v135 offset:20480
    v_mfma_f32_16x16x32_bf16 v[156:159], v[148:151], v[104:107], v[156:159]
    v_mfma_f32_32x32x16_bf16 v[64:79], v[108:111], v[100:103], v[64:79]
    v_mfma_f32_16x16x32_bf16 v[156:159], v[152:155], v[108:111], v[156:159]
    s_waitcnt lgkmcnt(6)
    v_mfma_f32_32x32x16_bf16 v[16:31], v[120:123], v[112:115], v[16:31]
    s_waitcnt lgkmcnt(0)
    s_barrier
    ds_read_b128 v[96:99], v136 offset:32768
    ds_read_b64_tr_b16 v[104:105], v142 offset:0
    v_mfma_f32_32x32x16_bf16 v[32:47], v[124:127], v[112:115], v[32:47]
    ds_read_b64_tr_b16 v[106:107], v142 offset:512
    ds_read_b64_tr_b16 v[108:109], v142 offset:8192
    v_mfma_f32_32x32x16_bf16 v[48:63], v[120:123], v[116:119], v[48:63]
    ds_read_b64_tr_b16 v[110:111], v142 offset:8704
    ds_read_b128 v[100:103], v136 offset:36864
    v_mfma_f32_32x32x16_bf16 v[64:79], v[124:127], v[116:119], v[64:79]
    v_mfma_f32_32x32x16_bf16 v[16:31], v[88:91], v[80:83], v[16:31]
    ds_read_b128 v[112:115], v137 offset:32768
    ds_read_b64_tr_b16 v[120:121], v142 offset:2048
    v_mfma_f32_32x32x16_bf16 v[32:47], v[92:95], v[80:83], v[32:47]
    ds_read_b64_tr_b16 v[122:123], v142 offset:2560
    ds_read_b64_tr_b16 v[124:125], v142 offset:10240
    v_mfma_f32_32x32x16_bf16 v[48:63], v[88:91], v[84:87], v[48:63]
    ds_read_b64_tr_b16 v[126:127], v142 offset:10752
    ds_read_b128 v[116:119], v137 offset:36864
    v_mfma_f32_32x32x16_bf16 v[64:79], v[92:95], v[84:87], v[64:79]
    s_waitcnt lgkmcnt(6)
    v_mfma_f32_32x32x16_bf16 v[16:31], v[104:107], v[96:99], v[16:31]
    ds_read_b128 v[80:83], v138 offset:32768
    ds_read_b64_tr_b16 v[88:89], v143 offset:0
    v_mfma_f32_32x32x16_bf16 v[32:47], v[108:111], v[96:99], v[32:47]
    ds_read_b64_tr_b16 v[90:91], v143 offset:512
    ds_read_b64_tr_b16 v[92:93], v143 offset:8192
    v_mfma_f32_32x32x16_bf16 v[48:63], v[104:107], v[100:103], v[48:63]
    ds_read_b64_tr_b16 v[94:95], v143 offset:8704
    ds_read_b128 v[84:87], v138 offset:36864
    v_mfma_f32_16x16x32_bf16 v[156:159], v[148:151], v[104:107], v[156:159]
    v_mfma_f32_32x32x16_bf16 v[64:79], v[108:111], v[100:103], v[64:79]
    buffer_load_dwordx2 v[190:191], v174, s[20:23], 0 offen sc1
    v_mfma_f32_16x16x32_bf16 v[156:159], v[152:155], v[108:111], v[156:159]
    s_waitcnt lgkmcnt(6)
    v_mfma_f32_32x32x16_bf16 v[16:31], v[120:123], v[112:115], v[16:31]
    ds_read_b128 v[96:99], v139 offset:32768
    ds_read_b64_tr_b16 v[104:105], v143 offset:2048
    v_mfma_f32_32x32x16_bf16 v[32:47], v[124:127], v[112:115], v[32:47]
    ds_read_b64_tr_b16 v[106:107], v143 offset:2560
    ds_read_b64_tr_b16 v[108:109], v143 offset:10240
    v_mfma_f32_32x32x16_bf16 v[48:63], v[120:123], v[116:119], v[48:63]
    ds_read_b64_tr_b16 v[110:111], v143 offset:10752
    ds_read_b128 v[100:103], v139 offset:36864
    v_mfma_f32_16x16x32_bf16 v[156:159], v[148:151], v[120:123], v[156:159]
    v_mfma_f32_32x32x16_bf16 v[64:79], v[124:127], v[116:119], v[64:79]
    v_mfma_f32_16x16x32_bf16 v[156:159], v[152:155], v[124:127], v[156:159]
    s_waitcnt lgkmcnt(6)
    v_mfma_f32_32x32x16_bf16 v[16:31], v[88:91], v[80:83], v[16:31]
    s_waitcnt lgkmcnt(0)
    s_barrier
    ds_read_b128 v[112:115], v128 offset:0
    ds_read_b64_tr_b16 v[120:121], v144 offset:16384
    v_mfma_f32_32x32x16_bf16 v[32:47], v[92:95], v[80:83], v[32:47]
    ds_read_b64_tr_b16 v[122:123], v144 offset:16896
    ds_read_b64_tr_b16 v[124:125], v144 offset:24576
    v_mfma_f32_32x32x16_bf16 v[48:63], v[88:91], v[84:87], v[48:63]
    ds_read_b64_tr_b16 v[126:127], v144 offset:25088
    ds_read_b128 v[116:119], v128 offset:4096
    v_mfma_f32_32x32x16_bf16 v[64:79], v[92:95], v[84:87], v[64:79]
    v_mfma_f32_32x32x16_bf16 v[16:31], v[104:107], v[96:99], v[16:31]
    ds_read_b128 v[80:83], v129 offset:0
    ds_read_b64_tr_b16 v[88:89], v144 offset:18432
    v_mfma_f32_32x32x16_bf16 v[32:47], v[108:111], v[96:99], v[32:47]
    ds_read_b64_tr_b16 v[90:91], v144 offset:18944
    ds_read_b64_tr_b16 v[92:93], v144 offset:26624
    v_mfma_f32_32x32x16_bf16 v[48:63], v[104:107], v[100:103], v[48:63]
    ds_read_b64_tr_b16 v[94:95], v144 offset:27136
    ds_read_b128 v[84:87], v129 offset:4096
    v_mfma_f32_32x32x16_bf16 v[64:79], v[108:111], v[100:103], v[64:79]
    s_waitcnt lgkmcnt(6)
    v_mfma_f32_32x32x16_bf16 v[16:31], v[120:123], v[112:115], v[16:31]
    ds_read_b128 v[96:99], v130 offset:0
    ds_read_b64_tr_b16 v[104:105], v145 offset:16384
    v_mfma_f32_32x32x16_bf16 v[32:47], v[124:127], v[112:115], v[32:47]
    ds_read_b64_tr_b16 v[106:107], v145 offset:16896
    ds_read_b64_tr_b16 v[108:109], v145 offset:24576
    v_mfma_f32_32x32x16_bf16 v[48:63], v[120:123], v[116:119], v[48:63]
    ds_read_b64_tr_b16 v[110:111], v145 offset:25088
    ds_read_b128 v[100:103], v130 offset:4096
    v_mfma_f32_16x16x32_bf16 v[156:159], v[148:151], v[120:123], v[156:159]
    v_mfma_f32_32x32x16_bf16 v[64:79], v[124:127], v[116:119], v[64:79]
    v_mfma_f32_16x16x32_bf16 v[156:159], v[152:155], v[124:127], v[156:159]
    s_waitcnt lgkmcnt(6)
    v_mfma_f32_32x32x16_bf16 v[16:31], v[88:91], v[80:83], v[16:31]
    ds_read_b128 v[112:115], v131 offset:0
    ds_read_b64_tr_b16 v[120:121], v145 offset:18432
    v_mfma_f32_32x32x16_bf16 v[32:47], v[92:95], v[80:83], v[32:47]
    ds_read_b64_tr_b16 v[122:123], v145 offset:18944
    ds_read_b64_tr_b16 v[124:125], v145 offset:26624
    v_mfma_f32_32x32x16_bf16 v[48:63], v[88:91], v[84:87], v[48:63]
    ds_read_b64_tr_b16 v[126:127], v145 offset:27136
    ds_read_b128 v[116:119], v131 offset:4096
    v_mfma_f32_16x16x32_bf16 v[156:159], v[148:151], v[88:91], v[156:159]
    v_mfma_f32_32x32x16_bf16 v[64:79], v[92:95], v[84:87], v[64:79]
    v_mfma_f32_16x16x32_bf16 v[156:159], v[152:155], v[92:95], v[156:159]
    s_waitcnt lgkmcnt(6)
    v_mfma_f32_32x32x16_bf16 v[16:31], v[104:107], v[96:99], v[16:31]
    s_waitcnt lgkmcnt(0)
    s_barrier
    ds_read_b128 v[80:83], v128 offset:16384
    ds_read_b64_tr_b16 v[88:89], v144 offset:0
    v_mfma_f32_32x32x16_bf16 v[32:47], v[108:111], v[96:99], v[32:47]
    ds_read_b64_tr_b16 v[90:91], v144 offset:512
    ds_read_b64_tr_b16 v[92:93], v144 offset:8192
    v_mfma_f32_32x32x16_bf16 v[48:63], v[104:107], v[100:103], v[48:63]
    ds_read_b64_tr_b16 v[94:95], v144 offset:8704
    ds_read_b128 v[84:87], v128 offset:20480
    v_mfma_f32_32x32x16_bf16 v[64:79], v[108:111], v[100:103], v[64:79]
    v_mfma_f32_32x32x16_bf16 v[16:31], v[120:123], v[112:115], v[16:31]
    ds_read_b128 v[96:99], v129 offset:16384
    ds_read_b64_tr_b16 v[104:105], v144 offset:2048
    v_mfma_f32_32x32x16_bf16 v[32:47], v[124:127], v[112:115], v[32:47]
    ds_read_b64_tr_b16 v[106:107], v144 offset:2560
    ds_read_b64_tr_b16 v[108:109], v144 offset:10240
    v_mfma_f32_32x32x16_bf16 v[48:63], v[120:123], v[116:119], v[48:63]
    ds_read_b64_tr_b16 v[110:111], v144 offset:10752
    ds_read_b128 v[100:103], v129 offset:20480
    v_mfma_f32_32x32x16_bf16 v[64:79], v[124:127], v[116:119], v[64:79]
    s_waitcnt lgkmcnt(6)
    v_mfma_f32_32x32x16_bf16 v[16:31], v[88:91], v[80:83], v[16:31]
    ds_read_b128 v[112:115], v130 offset:16384
    ds_read_b64_tr_b16 v[120:121], v145 offset:0
    v_mfma_f32_32x32x16_bf16 v[32:47], v[92:95], v[80:83], v[32:47]
    ds_read_b64_tr_b16 v[122:123], v145 offset:512
    ds_read_b64_tr_b16 v[124:125], v145 offset:8192
    v_mfma_f32_32x32x16_bf16 v[48:63], v[88:91], v[84:87], v[48:63]
    ds_read_b64_tr_b16 v[126:127], v145 offset:8704
    ds_read_b128 v[116:119], v130 offset:20480
    v_mfma_f32_16x16x32_bf16 v[156:159], v[148:151], v[88:91], v[156:159]
    v_mfma_f32_32x32x16_bf16 v[64:79], v[92:95], v[84:87], v[64:79]
    v_mfma_f32_16x16x32_bf16 v[156:159], v[152:155], v[92:95], v[156:159]
    s_waitcnt lgkmcnt(6)
    v_mfma_f32_32x32x16_bf16 v[16:31], v[104:107], v[96:99], v[16:31]
    ds_read_b128 v[80:83], v131 offset:16384
    ds_read_b64_tr_b16 v[88:89], v145 offset:2048
    v_mfma_f32_32x32x16_bf16 v[32:47], v[108:111], v[96:99], v[32:47]
    ds_read_b64_tr_b16 v[90:91], v145 offset:2560
    ds_read_b64_tr_b16 v[92:93], v145 offset:10240
    v_mfma_f32_32x32x16_bf16 v[48:63], v[104:107], v[100:103], v[48:63]
    ds_read_b64_tr_b16 v[94:95], v145 offset:10752
    ds_read_b128 v[84:87], v131 offset:20480
    v_mfma_f32_16x16x32_bf16 v[156:159], v[148:151], v[104:107], v[156:159]
    v_mfma_f32_32x32x16_bf16 v[64:79], v[108:111], v[100:103], v[64:79]
    v_mfma_f32_16x16x32_bf16 v[156:159], v[152:155], v[108:111], v[156:159]
    s_waitcnt lgkmcnt(6)
    v_mfma_f32_32x32x16_bf16 v[16:31], v[120:123], v[112:115], v[16:31]
    s_nop 5
    ds_write_b32 v168, v156
    s_waitcnt lgkmcnt(0)
    s_barrier
    ds_read_b32 v136, v169
    ds_read_b32 v137, v169 offset:128
    v_mov_b32 v129, 0
    v_mov_b32 v130, 0
    v_mov_b32 v131, 0
    v_mfma_f32_32x32x16_bf16 v[32:47], v[124:127], v[112:115], v[32:47]
    v_mov_b32 v133, 0
    v_mov_b32 v134, 0
    v_mov_b32 v135, 0
    v_mfma_f32_32x32x16_bf16 v[48:63], v[120:123], v[116:119], v[48:63]
    v_mfma_f32_32x32x16_bf16 v[64:79], v[124:127], v[116:119], v[64:79]
    v_mfma_f32_32x32x16_bf16 v[16:31], v[88:91], v[80:83], v[16:31]
    s_waitcnt lgkmcnt(0)
    v_cvt_pk_bf16_f32 v138, v136, v136
    v_and_b32 v138, s66, v138
    v_sub_f32 v138, v136, v138
    v_mfma_f32_32x32x16_bf16 v[32:47], v[92:95], v[80:83], v[32:47]
    v_cvt_pk_bf16_f32 v128, v136, v138
    v_cvt_pk_bf16_f32 v139, v137, v137
    v_and_b32 v139, s66, v139
    v_mfma_f32_32x32x16_bf16 v[48:63], v[88:91], v[84:87], v[48:63]
    v_sub_f32 v139, v137, v139
    v_cvt_pk_bf16_f32 v132, v137, v139
    v_mfma_f32_32x32x16_bf16 v[64:79], v[92:95], v[84:87], v[64:79]
    v_mfma_f32_32x32x16_bf16 v[16:31], v[128:131], v[182:185], v[16:31]
    v_mfma_f32_32x32x16_bf16 v[32:47], v[132:135], v[182:185], v[32:47]
    v_mfma_f32_32x32x16_bf16 v[48:63], v[128:131], v[184:187], v[48:63]
    v_mfma_f32_32x32x16_bf16 v[64:79], v[132:135], v[184:187], v[64:79]
    s_cmp_eq_u32 s50, 7
    s_cselect_b32 vcc_lo, 1, 0
    s_cbranch_scc1 L_nopq
    s_waitcnt vmcnt(0)
    v_cmp_ne_u64 s[78:79], v[190:191], v[14:15]
    s_cmp_lg_u64 s[78:79], 0
    s_cbranch_scc1 L_ts17
L_tb16:
L_nopq:
    s_nop 7
    s_cbranch_vccnz L_sw19
    buffer_load_dwordx4 v[192:195], v6, s[20:23], s51 offen offset:0 sc1
L_sw19:
    v_mul_f32 v112, v16, v16
    v_mul_f32 v113, v17, v17
    v_mul_f32 v114, v18, v18
    v_mul_f32 v115, v19, v19
    v_mul_f32 v116, v20, v20
    v_mul_f32 v117, v21, v21
    v_mul_f32 v118, v22, v22
    v_mul_f32 v119, v23, v23
    v_fma_f32 v112, v112, v180, v178
    v_fma_f32 v113, v113, v180, v178
    v_fma_f32 v114, v114, v180, v178
    v_fma_f32 v115, v115, v180, v178
    v_fma_f32 v116, v116, v180, v178
    v_fma_f32 v117, v117, v180, v178
    v_fma_f32 v118, v118, v180, v178
    v_fma_f32 v119, v119, v180, v178
    v_mul_f32 v112, v112, v16
    v_mul_f32 v113, v113, v17
    v_mul_f32 v114, v114, v18
    v_mul_f32 v115, v115, v19
    v_mul_f32 v116, v116, v20
    v_mul_f32 v117, v117, v21
    v_mul_f32 v118, v118, v22
    v_mul_f32 v119, v119, v23
    v_exp_f32 v112, v112
    v_mul_f32 v16, v16, v32
    v_exp_f32 v113, v113
    v_mul_f32 v17, v17, v33
    v_exp_f32 v114, v114
    v_mul_f32 v18, v18, v34
    v_exp_f32 v115, v115
    v_mul_f32 v19, v19, v35
    v_exp_f32 v116, v116
    v_mul_f32 v20, v20, v36
    v_exp_f32 v117, v117
    v_mul_f32 v21, v21, v37
    v_exp_f32 v118, v118
    v_mul_f32 v22, v22, v38
    v_exp_f32 v119, v119
    v_mul_f32 v23, v23, v39
    v_fma_f32 v112, v112, v176, v176
    v_fma_f32 v113, v113, v176, v176
    v_fma_f32 v114, v114, v176, v176
    v_fma_f32 v115, v115, v176, v176
    v_fma_f32 v116, v116, v176, v176
    v_fma_f32 v117, v117, v176, v176
    v_fma_f32 v118, v118, v176, v176
    v_fma_f32 v119, v119, v176, v176
    v_rcp_f32 v112, v112
    v_rcp_f32 v113, v113
    v_rcp_f32 v114, v114
    v_rcp_f32 v115, v115
    v_rcp_f32 v116, v116
    v_rcp_f32 v117, v117
    v_rcp_f32 v118, v118
    v_rcp_f32 v119, v119
    v_mul_f32 v16, v16, v112
    v_mul_f32 v17, v17, v113
    v_mul_f32 v18, v18, v114
    v_mul_f32 v19, v19, v115
    v_mul_f32 v20, v20, v116
    v_mul_f32 v21, v21, v117
    v_mul_f32 v22, v22, v118
    v_mul_f32 v23, v23, v119
    v_cvt_pk_bf16_f32 v120, v16, v17
    v_cvt_pk_bf16_f32 v121, v18, v19
    v_cvt_pk_bf16_f32 v122, v20, v21
    v_cvt_pk_bf16_f32 v123, v22, v23
    buffer_store_dwordx4 v[120:123], v6, s[20:23], s74 offen offset:0 sc1
    s_cbranch_vccnz L_sw20
    buffer_load_dwordx4 v[196:199], v6, s[20:23], s51 offen offset:1024 sc1
L_sw20:
    v_mul_f32 v112, v24, v24
    v_mul_f32 v113, v25, v25
    v_mul_f32 v114, v26, v26
    v_mul_f32 v115, v27, v27
    v_mul_f32 v116, v28, v28
    v_mul_f32 v117, v29, v29
    v_mul_f32 v118, v30, v30
    v_mul_f32 v119, v31, v31
    v_fma_f32 v112, v112, v180, v178
    v_fma_f32 v113, v113, v180, v178
    v_fma_f32 v114, v114, v180, v178
    v_fma_f32 v115, v115, v180, v178
    v_fma_f32 v116, v116, v180, v178
    v_fma_f32 v117, v117, v180, v178
    v_fma_f32 v118, v118, v180, v178
    v_fma_f32 v119, v119, v180, v178
    v_mul_f32 v112, v112, v24
    v_mul_f32 v113, v113, v25
    v_mul_f32 v114, v114, v26
    v_mul_f32 v115, v115, v27
    v_mul_f32 v116, v116, v28
    v_mul_f32 v117, v117, v29
    v_mul_f32 v118, v118, v30
    v_mul_f32 v119, v119, v31
    v_exp_f32 v112, v112
    v_mul_f32 v24, v24, v40
    v_exp_f32 v113, v113
    v_mul_f32 v25, v25, v41
    v_exp_f32 v114, v114
    v_mul_f32 v26, v26, v42
    v_exp_f32 v115, v115
    v_mul_f32 v27, v27, v43
    v_exp_f32 v116, v116
    v_mul_f32 v28, v28, v44
    v_exp_f32 v117, v117
    v_mul_f32 v29, v29, v45
    v_exp_f32 v118, v118
    v_mul_f32 v30, v30, v46
    v_exp_f32 v119, v119
    v_mul_f32 v31, v31, v47
    v_fma_f32 v112, v112, v176, v176
    v_fma_f32 v113, v113, v176, v176
    v_fma_f32 v114, v114, v176, v176
    v_fma_f32 v115, v115, v176, v176
    v_fma_f32 v116, v116, v176, v176
    v_fma_f32 v117, v117, v176, v176
    v_fma_f32 v118, v118, v176, v176
    v_fma_f32 v119, v119, v176, v176
    v_rcp_f32 v112, v112
    v_rcp_f32 v113, v113
    v_rcp_f32 v114, v114
    v_rcp_f32 v115, v115
    v_rcp_f32 v116, v116
    v_rcp_f32 v117, v117
    v_rcp_f32 v118, v118
    v_rcp_f32 v119, v119
    v_mul_f32 v24, v24, v112
    v_mul_f32 v25, v25, v113
    v_mul_f32 v26, v26, v114
    v_mul_f32 v27, v27, v115
    v_mul_f32 v28, v28, v116
    v_mul_f32 v29, v29, v117
    v_mul_f32 v30, v30, v118
    v_mul_f32 v31, v31, v119
    v_cvt_pk_bf16_f32 v124, v24, v25
    v_cvt_pk_bf16_f32 v125, v26, v27
    v_cvt_pk_bf16_f32 v126, v28, v29
    v_cvt_pk_bf16_f32 v127, v30, v31
    buffer_store_dwordx4 v[124:127], v6, s[20:23], s74 offen offset:1024 sc1
    s_cbranch_vccnz L_sw21
    buffer_load_dwordx4 v[200:203], v6, s[20:23], s51 offen offset:2048 sc1
L_sw21:
    v_mul_f32 v112, v48, v48
    v_mul_f32 v113, v49, v49
    v_mul_f32 v114, v50, v50
    v_mul_f32 v115, v51, v51
    v_mul_f32 v116, v52, v52
    v_mul_f32 v117, v53, v53
    v_mul_f32 v118, v54, v54
    v_mul_f32 v119, v55, v55
    v_fma_f32 v112, v112, v181, v179
    v_fma_f32 v113, v113, v181, v179
    v_fma_f32 v114, v114, v181, v179
    v_fma_f32 v115, v115, v181, v179
    v_fma_f32 v116, v116, v181, v179
    v_fma_f32 v117, v117, v181, v179
    v_fma_f32 v118, v118, v181, v179
    v_fma_f32 v119, v119, v181, v179
    v_mul_f32 v112, v112, v48
    v_mul_f32 v113, v113, v49
    v_mul_f32 v114, v114, v50
    v_mul_f32 v115, v115, v51
    v_mul_f32 v116, v116, v52
    v_mul_f32 v117, v117, v53
    v_mul_f32 v118, v118, v54
    v_mul_f32 v119, v119, v55
    v_exp_f32 v112, v112
    v_mul_f32 v48, v48, v64
    v_exp_f32 v113, v113
    v_mul_f32 v49, v49, v65
    v_exp_f32 v114, v114
    v_mul_f32 v50, v50, v66
    v_exp_f32 v115, v115
    v_mul_f32 v51, v51, v67
    v_exp_f32 v116, v116
    v_mul_f32 v52, v52, v68
    v_exp_f32 v117, v117
    v_mul_f32 v53, v53, v69
    v_exp_f32 v118, v118
    v_mul_f32 v54, v54, v70
    v_exp_f32 v119, v119
    v_mul_f32 v55, v55, v71
    v_fma_f32 v112, v112, v177, v177
    v_fma_f32 v113, v113, v177, v177
    v_fma_f32 v114, v114, v177, v177
    v_fma_f32 v115, v115, v177, v177
    v_fma_f32 v116, v116, v177, v177
    v_fma_f32 v117, v117, v177, v177
    v_fma_f32 v118, v118, v177, v177
    v_fma_f32 v119, v119, v177, v177
    v_rcp_f32 v112, v112
    v_rcp_f32 v113, v113
    v_rcp_f32 v114, v114
    v_rcp_f32 v115, v115
    v_rcp_f32 v116, v116
    v_rcp_f32 v117, v117
    v_rcp_f32 v118, v118
    v_rcp_f32 v119, v119
    v_mul_f32 v48, v48, v112
    v_mul_f32 v49, v49, v113
    v_mul_f32 v50, v50, v114
    v_mul_f32 v51, v51, v115
    v_mul_f32 v52, v52, v116
    v_mul_f32 v53, v53, v117
    v_mul_f32 v54, v54, v118
    v_mul_f32 v55, v55, v119
    v_cvt_pk_bf16_f32 v120, v48, v49
    v_cvt_pk_bf16_f32 v121, v50, v51
    v_cvt_pk_bf16_f32 v122, v52, v53
    v_cvt_pk_bf16_f32 v123, v54, v55
    buffer_store_dwordx4 v[120:123], v6, s[20:23], s75 offen offset:0 sc1
    s_cbranch_vccnz L_sw22
    buffer_load_dwordx4 v[204:207], v6, s[20:23], s51 offen offset:3072 sc1
    s_add_u32 s51, s51, 4096
L_sw22:
    v_mul_f32 v112, v56, v56
    v_mul_f32 v113, v57, v57
    v_mul_f32 v114, v58, v58
    v_mul_f32 v115, v59, v59
    v_mul_f32 v116, v60, v60
    v_mul_f32 v117, v61, v61
    v_mul_f32 v118, v62, v62
    v_mul_f32 v119, v63, v63
    v_fma_f32 v112, v112, v181, v179
    v_fma_f32 v113, v113, v181, v179
    v_fma_f32 v114, v114, v181, v179
    v_fma_f32 v115, v115, v181, v179
    v_fma_f32 v116, v116, v181, v179
    v_fma_f32 v117, v117, v181, v179
    v_fma_f32 v118, v118, v181, v179
    v_fma_f32 v119, v119, v181, v179
    v_mul_f32 v112, v112, v56
    v_mul_f32 v113, v113, v57
    v_mul_f32 v114, v114, v58
    v_mul_f32 v115, v115, v59
    v_mul_f32 v116, v116, v60
    v_mul_f32 v117, v117, v61
    v_mul_f32 v118, v118, v62
    v_mul_f32 v119, v119, v63
    v_exp_f32 v112, v112
    v_mul_f32 v56, v56, v72
    v_exp_f32 v113, v113
    v_mul_f32 v57, v57, v73
    v_exp_f32 v114, v114
    v_mul_f32 v58, v58, v74
    v_exp_f32 v115, v115
    v_mul_f32 v59, v59, v75
    v_exp_f32 v116, v116
    v_mul_f32 v60, v60, v76
    v_exp_f32 v117, v117
    v_mul_f32 v61, v61, v77
    v_exp_f32 v118, v118
    v_mul_f32 v62, v62, v78
    v_exp_f32 v119, v119
    v_mul_f32 v63, v63, v79
    v_fma_f32 v112, v112, v177, v177
    v_fma_f32 v113, v113, v177, v177
    v_fma_f32 v114, v114, v177, v177
    v_fma_f32 v115, v115, v177, v177
    v_fma_f32 v116, v116, v177, v177
    v_fma_f32 v117, v117, v177, v177
    v_fma_f32 v118, v118, v177, v177
    v_fma_f32 v119, v119, v177, v177
    v_rcp_f32 v112, v112
    v_rcp_f32 v113, v113
    v_rcp_f32 v114, v114
    v_rcp_f32 v115, v115
    v_rcp_f32 v116, v116
    v_rcp_f32 v117, v117
    v_rcp_f32 v118, v118
    v_rcp_f32 v119, v119
    v_mul_f32 v56, v56, v112
    v_mul_f32 v57, v57, v113
    v_mul_f32 v58, v58, v114
    v_mul_f32 v59, v59, v115
    v_mul_f32 v60, v60, v116
    v_mul_f32 v61, v61, v117
    v_mul_f32 v62, v62, v118
    v_mul_f32 v63, v63, v119
    v_cvt_pk_bf16_f32 v124, v56, v57
    v_cvt_pk_bf16_f32 v125, v58, v59
    v_cvt_pk_bf16_f32 v126, v60, v61
    v_cvt_pk_bf16_f32 v127, v62, v63
    buffer_store_dwordx4 v[124:127], v6, s[20:23], s75 offen offset:1024 sc1
    s_cbranch_vccnz L_p2
    buffer_load_dwordx4 v[208:211], v6, s[20:23], s51 offen offset:0 sc1
    s_mov_b32 s8, s26
    s_mov_b32 s9, s27
    s_mov_b32 s10, 2097152
    s_mov_b32 s11, 0x20000
    s_and_b32 s65, s68, 1
    s_lshl_b32 s72, s65, 9
    s_add_u32 s72, s72, s70
    s_lshl_b32 s72, s72, 10
    buffer_load_dwordx4 v[212:215], v6, s[20:23], s51 offen offset:1024 sc1
    s_lshl_b32 s64, s69, 7
    s_add_u32 s72, s72, s64
    v_bfe_u32 v2, v0, 3, 5
    v_lshrrev_b32 v3, 8, v0
    v_lshlrev_b32 v7, 14, v2
    v_lshl_add_u32 v7, v3, 20, v7
    v_and_b32 v3, 7, v0
    v_lshl_add_u32 v7, v3, 4, v7
    buffer_load_dwordx4 v[216:219], v6, s[20:23], s51 offen offset:2048 sc1
    v_add_u32 v5, 229376, v6
    s_lshl_b32 s64, s70, 2
    s_add_u32 s64, s64, s65
    s_mul_i32 s64, s64, 114688
    s_lshl_b32 s65, s50, 15
    s_add_u32 s64, s64, s65
    s_cmp_ge_u32 s50, 4
    s_cselect_b32 s65, 110592, 0
    s_sub_u32 s74, s64, s65
    buffer_load_dwordx4 v[220:223], v6, s[20:23], s51 offen offset:3072 sc1
    s_add_u32 s51, s51, 4096
    s_cmp_ge_u32 s50, 4
    s_cselect_b32 s65, 110592, 0
    s_sub_u32 s75, s64, s65
    s_add_u32 s75, s75, 8192
    s_cmp_ge_u32 s50, 3
    s_cselect_b32 s65, 110592, 0
    s_sub_u32 s76, s64, s65
    s_add_u32 s76, s76, 16384
    s_cmp_ge_u32 s50, 3
    s_cselect_b32 s65, 110592, 0
    s_sub_u32 s77, s64, s65
    s_add_u32 s77, s77, 24576
    s_waitcnt vmcnt(4)
    v_mov_b32 v2, 147460
    v_mov_b32 v3, 1
    s_mov_b64 exec, 1
    ds_add_rtn_u32 v3, v2, v3
    s_waitcnt lgkmcnt(0)
    v_readfirstlane_b32 s73, v3
    s_mov_b64 exec, -1
    s_cmp_lg_u32 s73, s3
    s_cbranch_scc1 L_ar23
    s_atomic_swap_x2 s[34:35], s[30:31], s55
L_ar23:
    s_setprio 1
    buffer_load_dwordx4 v[224:227], v6, s[20:23], s51 offen offset:0 sc1
    buffer_load_dwordx4 v[228:231], v6, s[20:23], s51 offen offset:1024 sc1
    buffer_load_dwordx4 v[232:235], v6, s[20:23], s51 offen offset:2048 sc1
    buffer_load_dwordx4 v[236:239], v6, s[20:23], s51 offen offset:3072 sc1
    s_add_u32 s51, s51, 4096
    buffer_load_dwordx4 v[240:243], v6, s[20:23], s51 offen offset:0 sc1
    buffer_load_dwordx4 v[244:247], v6, s[20:23], s51 offen offset:1024 sc1
    buffer_load_dwordx4 v[248:251], v6, s[20:23], s51 offen offset:2048 sc1
    buffer_load_dwordx4 v[252:255], v6, s[20:23], s51 offen offset:3072 sc1
    s_add_u32 s51, s51, 4096
    s_branch L_rest
L_dft:
    s_cbranch_vccnz L_sk35
    s_mov_b32 m0, s57
    s_mov_b32 s53, 0
    buffer_load_dwordx4 v164, s[12:15], s53 offen lds
    s_add_u32 m0, s57, 8192
    s_nop 0
    buffer_load_dwordx4 v164, s[16:19], s53 offen lds
    s_add_u32 m0, s57, 4096
    s_nop 0
    buffer_load_dwordx4 v165, s[12:15], s53 offen lds
    s_add_u32 m0, s57, 12288
    s_nop 0
    buffer_load_dwordx4 v165, s[16:19], s53 offen lds
    s_add_u32 m0, s57, 98304
    s_movk_i32 s56, 0
    buffer_load_dwordx4 v160, s[4:7], s56 offen lds
    s_add_u32 m0, s57, 102400
    s_nop 0
    buffer_load_dwordx4 v161, s[4:7], s56 offen lds
    s_add_u32 m0, s57, 106496
    s_nop 0
    buffer_load_dwordx4 v162, s[4:7], s56 offen lds
    s_add_u32 m0, s57, 110592
    s_nop 0
    buffer_load_dwordx4 v163, s[4:7], s56 offen lds
L_sk35:
    v_lshrrev_b32 v2, 5, v1
    v_and_b32 v3, 31, v1
    v_bfe_u32 v5, v1, 2, 2
    v_lshlrev_b32 v4, 11, v2
    v_lshl_add_u32 v4, v5, 8, v4
    v_xor_b32 v5, s63, v5
    v_lshl_add_u32 v4, v5, 6, v4
    v_bfe_u32 v5, v1, 4, 1
    v_lshl_add_u32 v4, v5, 5, v4
    v_and_b32 v5, 3, v1
    v_lshl_add_u32 v124, v5, 3, v4
    v_add_u32 v125, 49152, v124
    v_bfe_u32 v4, v1, 1, 3
    v_xor_b32 v4, v4, v2
    v_lshlrev_b32 v4, 4, v4
    v_lshl_add_u32 v4, v3, 7, v4
    s_lshl_b32 s64, s62, 13
    s_add_u32 s64, s64, 98304
    v_add_u32 v4, s64, v4
    v_xor_b32 v116, 0, v4
    v_xor_b32 v117, 32, v4
    v_xor_b32 v118, 64, v4
    v_xor_b32 v119, 96, v4
    s_lshl_b32 s64, s49, 3
    s_add_u32 s64, s64, s50
    s_lshl_b32 s64, s64, 4
    s_add_u32 s64, s64, s48
    s_lshl_b32 s64, s64, 10
    v_lshlrev_b32 v6, 4, v1
    v_mov_b32 v166, 0
    v_mov_b32 v167, 0
    v_mov_b32 v4, 147456
    ds_write_b64 v4, v[166:167]
    s_cbranch_vccnz L_sk36
    s_add_u32 m0, s57, 16384
    s_mov_b32 s53, 32768
    buffer_load_dwordx4 v164, s[12:15], s53 offen lds
    s_add_u32 m0, s57, 24576
    s_nop 0
    buffer_load_dwordx4 v164, s[16:19], s53 offen lds
    s_add_u32 m0, s57, 20480
    s_nop 0
    buffer_load_dwordx4 v165, s[12:15], s53 offen lds
    s_add_u32 m0, s57, 28672
    s_nop 0
    buffer_load_dwordx4 v165, s[16:19], s53 offen lds
    s_add_u32 m0, s57, 32768
    s_mov_b32 s53, 65536
    buffer_load_dwordx4 v164, s[12:15], s53 offen lds
    s_add_u32 m0, s57, 40960
    s_nop 0
    buffer_load_dwordx4 v164, s[16:19], s53 offen lds
    s_add_u32 m0, s57, 36864
    s_nop 0
    buffer_load_dwordx4 v165, s[12:15], s53 offen lds
    s_add_u32 m0, s57, 45056
    s_nop 0
    buffer_load_dwordx4 v165, s[16:19], s53 offen lds
L_sk36:
    buffer_load_dwordx4 v[192:195], v6, s[4:7], s64 offen
    v_lshrrev_b32 v4, 1, v1
    s_lshl_b32 s64, s48, 5
    v_add_u32 v4, s64, v4
    v_lshlrev_b32 v4, 10, v4
    v_and_b32 v5, 1, v1
    v_lshl_add_u32 v4, v5, 7, v4
    s_cmp_lg_u32 s50, 4
    s_cbranch_scc1 L_dt1
    buffer_load_dword v189, v4, s[12:15], s59 offen
L_dt1:
    s_cmp_lg_u32 s50, 5
    s_cbranch_scc1 L_dt2
    buffer_load_dword v189, v4, s[16:19], s59 offen
L_dt2:
    s_waitcnt vmcnt(9) lgkmcnt(0)
    s_barrier
    ds_read_b128 v[80:83], v116 offset:0
    ds_read_b64_tr_b16 v[88:89], v124 offset:0
    ds_read_b64_tr_b16 v[90:91], v124 offset:1024
    ds_read_b64_tr_b16 v[92:93], v124 offset:8192
    ds_read_b64_tr_b16 v[94:95], v124 offset:9216
    ds_read_b128 v[84:87], v116 offset:4096
    s_waitcnt lgkmcnt(3)
    v_mfma_f32_32x32x16_bf16 v[16:31], v[80:83], v[88:91], 0
    ds_read_b128 v[96:99], v117 offset:0
    ds_read_b64_tr_b16 v[104:105], v124 offset:4096
    ds_read_b64_tr_b16 v[106:107], v124 offset:5120
    s_mov_b32 s20, s30
    s_mov_b32 s21, s31
    s_mov_b32 s22, 12582912
    s_mov_b32 s23, 0x20000
    s_mov_b32 s66, 0xffff0000
    s_waitcnt lgkmcnt(4)
    v_mfma_f32_32x32x16_bf16 v[32:47], v[80:83], v[92:95], 0
    ds_read_b64_tr_b16 v[108:109], v124 offset:12288
    ds_read_b64_tr_b16 v[110:111], v124 offset:13312
    ds_read_b128 v[100:103], v117 offset:4096
    s_lshl_b32 s72, s48, 4
    s_add_u32 s72, s72, s49
    s_lshl_b32 s72, s72, 7
    s_add_u32 s72, s72, 9510912
    s_bfe_u32 s69, s2, 0x30003
    s_waitcnt lgkmcnt(6)
    v_mfma_f32_32x32x16_bf16 v[48:63], v[84:87], v[88:91], 0
    s_and_b32 s68, s2, 7
    s_lshl_b32 s68, s68, 2
    s_lshr_b32 s65, s2, 6
    s_add_u32 s68, s68, s65
    s_lshr_b32 s70, s68, 1
    s_cbranch_vccnz L_sk37
    s_add_u32 m0, s57, 114688
    s_movk_i32 s56, 128
    buffer_load_dwordx4 v160, s[4:7], s56 offen lds
    s_add_u32 m0, s57, 118784
    s_nop 0
    buffer_load_dwordx4 v161, s[4:7], s56 offen lds
L_sk37:
    v_mfma_f32_32x32x16_bf16 v[64:79], v[84:87], v[92:95], 0
    s_mul_i32 s64, s69, 7
    s_add_u32 s64, s64, s50
    s_lshl_b32 s51, s64, 15
    s_add_u32 s51, s51, 10485760
    s_lshl_b32 s64, s64, 9
    s_cbranch_vccnz L_sk38
    s_add_u32 m0, s57, 122880
    s_nop 0
    buffer_load_dwordx4 v162, s[4:7], s56 offen lds
    s_add_u32 m0, s57, 126976
    s_nop 0
    buffer_load_dwordx4 v163, s[4:7], s56 offen lds
L_sk38:
    s_waitcnt lgkmcnt(3)
    v_mfma_f32_32x32x16_bf16 v[16:31], v[96:99], v[104:107], v[16:31]
    s_waitcnt vmcnt(9) lgkmcnt(0)
    s_barrier
    ds_read_b128 v[80:83], v118 offset:0
    ds_read_b64_tr_b16 v[88:89], v124 offset:16384
    ds_read_b64_tr_b16 v[90:91], v124 offset:17408
    s_add_u32 s64, s64, 9629696
    v_and_b32 v4, 3, v1
    v_lshlrev_b32 v4, 7, v4
    v_add_u32 v174, s64, v4
    s_mul_i32 s64, s70, 3584
    v_mfma_f32_32x32x16_bf16 v[32:47], v[96:99], v[108:111], v[32:47]
    ds_read_b64_tr_b16 v[92:93], v124 offset:24576
    ds_read_b64_tr_b16 v[94:95], v124 offset:25600
    ds_read_b128 v[84:87], v118 offset:4096
    s_lshl_b32 s65, s50, 9
    s_add_u32 s64, s64, s65
    s_add_u32 s64, s64, 9572352
    s_add_u32 s36, s30, s64
    s_addc_u32 s37, s31, 0
    v_lshlrev_b32 v6, 4, v1
    v_mfma_f32_32x32x16_bf16 v[48:63], v[100:103], v[104:107], v[48:63]
    s_cbranch_vccnz L_sk39
    s_add_u32 m0, s57, 49152
    s_mov_b32 s53, 98304
    buffer_load_dwordx4 v164, s[12:15], s53 offen lds
    s_add_u32 m0, s57, 57344
    s_nop 0
    buffer_load_dwordx4 v164, s[16:19], s53 offen lds
L_sk39:
    v_mfma_f32_32x32x16_bf16 v[64:79], v[100:103], v[108:111], v[64:79]
    s_cbranch_vccnz L_sk40
    s_add_u32 m0, s57, 53248
    s_nop 0
    buffer_load_dwordx4 v165, s[12:15], s53 offen lds
    s_add_u32 m0, s57, 61440
    s_nop 0
    buffer_load_dwordx4 v165, s[16:19], s53 offen lds
L_sk40:
    s_waitcnt lgkmcnt(3)
    v_mfma_f32_32x32x16_bf16 v[16:31], v[80:83], v[88:91], v[16:31]
    ds_read_b128 v[96:99], v119 offset:0
    ds_read_b64_tr_b16 v[104:105], v124 offset:20480
    ds_read_b64_tr_b16 v[106:107], v124 offset:21504
    s_waitcnt lgkmcnt(4)
    v_mfma_f32_32x32x16_bf16 v[32:47], v[80:83], v[92:95], v[32:47]
    ds_read_b64_tr_b16 v[108:109], v124 offset:28672
    ds_read_b64_tr_b16 v[110:111], v124 offset:29696
    ds_read_b128 v[100:103], v119 offset:4096
    s_waitcnt lgkmcnt(6)
    v_mfma_f32_32x32x16_bf16 v[48:63], v[84:87], v[88:91], v[48:63]
    s_cbranch_vccnz L_sk41
    s_add_u32 m0, s57, 65536
    s_mov_b32 s53, 131072
    buffer_load_dwordx4 v164, s[12:15], s53 offen lds
    s_add_u32 m0, s57, 73728
    s_nop 0
    buffer_load_dwordx4 v164, s[16:19], s53 offen lds
L_sk41:
    v_mfma_f32_32x32x16_bf16 v[64:79], v[84:87], v[92:95], v[64:79]
    s_cbranch_vccnz L_sk42
    s_add_u32 m0, s57, 69632
    s_nop 0
    buffer_load_dwordx4 v165, s[12:15], s53 offen lds
    s_add_u32 m0, s57, 77824
    s_nop 0
    buffer_load_dwordx4 v165, s[16:19], s53 offen lds
L_sk42:
    s_waitcnt lgkmcnt(3)
    v_mfma_f32_32x32x16_bf16 v[16:31], v[96:99], v[104:107], v[16:31]
    s_waitcnt vmcnt(8) lgkmcnt(0)
    s_barrier
    ds_read_b128 v[80:83], v116 offset:16384
    ds_read_b64_tr_b16 v[88:89], v124 offset:32768
    ds_read_b64_tr_b16 v[90:91], v124 offset:33792
    v_mfma_f32_32x32x16_bf16 v[32:47], v[96:99], v[108:111], v[32:47]
    ds_read_b64_tr_b16 v[92:93], v124 offset:40960
    ds_read_b64_tr_b16 v[94:95], v124 offset:41984
    ds_read_b128 v[84:87], v116 offset:20480
    global_load_dwordx2 v[14:15], v166, s[24:25] sc1
    v_mfma_f32_32x32x16_bf16 v[48:63], v[100:103], v[104:107], v[48:63]
    s_cbranch_vccnz L_sk43
    s_add_u32 m0, s57, 131072
    s_movk_i32 s56, 256
    buffer_load_dwordx4 v160, s[4:7], s56 offen lds
    s_add_u32 m0, s57, 135168
    s_nop 0
    buffer_load_dwordx4 v161, s[4:7], s56 offen lds
L_sk43:
    v_mfma_f32_32x32x16_bf16 v[64:79], v[100:103], v[108:111], v[64:79]
    s_cbranch_vccnz L_sk44
    s_add_u32 m0, s57, 139264
    s_nop 0
    buffer_load_dwordx4 v162, s[4:7], s56 offen lds
    s_add_u32 m0, s57, 143360
    s_nop 0
    buffer_load_dwordx4 v163, s[4:7], s56 offen lds
L_sk44:
    s_cbranch_vccz L_hw45
    s_waitcnt vmcnt(1)
L_hw45:
    s_waitcnt lgkmcnt(3)
    v_mfma_f32_32x32x16_bf16 v[16:31], v[80:83], v[88:91], v[16:31]
    ds_read_b128 v[96:99], v117 offset:16384
    ds_read_b64_tr_b16 v[104:105], v124 offset:36864
    ds_read_b64_tr_b16 v[106:107], v124 offset:37888
    v_lshlrev_b32 v196, 16, v192
    v_and_b32 v197, s66, v192
    v_lshlrev_b32 v198, 16, v193
    v_and_b32 v199, s66, v193
    v_lshlrev_b32 v200, 16, v194
    s_waitcnt lgkmcnt(4)
    v_mfma_f32_32x32x16_bf16 v[32:47], v[80:83], v[92:95], v[32:47]
    ds_read_b64_tr_b16 v[108:109], v124 offset:45056
    ds_read_b64_tr_b16 v[110:111], v124 offset:46080
    ds_read_b128 v[100:103], v117 offset:20480
    v_and_b32 v201, s66, v194
    v_lshlrev_b32 v202, 16, v195
    v_and_b32 v203, s66, v195
    v_add_f32 v204, v196, v198
    v_mul_f32 v205, v196, v196
    s_waitcnt lgkmcnt(6)
    v_mfma_f32_32x32x16_bf16 v[48:63], v[84:87], v[88:91], v[48:63]
    v_add_f32 v206, v197, v199
    v_mul_f32 v207, v197, v197
    v_add_f32 v204, v204, v200
    v_add_f32 v206, v206, v201
    v_add_f32 v204, v204, v202
    s_cbranch_vccnz L_sk46
    s_add_u32 m0, s57, 81920
    s_mov_b32 s53, 163840
    buffer_load_dwordx4 v164, s[12:15], s53 offen lds
    s_add_u32 m0, s57, 90112
    s_nop 0
    buffer_load_dwordx4 v164, s[16:19], s53 offen lds
L_sk46:
    v_mfma_f32_32x32x16_bf16 v[64:79], v[84:87], v[92:95], v[64:79]
    v_add_f32 v206, v206, v203
    v_fmac_f32 v205, v198, v198
    v_fmac_f32 v207, v199, v199
    v_fmac_f32 v205, v200, v200
    v_fmac_f32 v207, v201, v201
    s_cbranch_vccnz L_sk47
    s_add_u32 m0, s57, 86016
    s_nop 0
    buffer_load_dwordx4 v165, s[12:15], s53 offen lds
    s_add_u32 m0, s57, 94208
    s_nop 0
    buffer_load_dwordx4 v165, s[16:19], s53 offen lds
L_sk47:
    s_waitcnt lgkmcnt(3)
    v_mfma_f32_32x32x16_bf16 v[16:31], v[96:99], v[104:107], v[16:31]
    s_waitcnt vmcnt(13) lgkmcnt(0)
    s_barrier
    ds_read_b128 v[80:83], v118 offset:16384
    ds_read_b64_tr_b16 v[88:89], v125 offset:0
    ds_read_b64_tr_b16 v[90:91], v125 offset:1024
    v_fmac_f32 v205, v202, v202
    v_fmac_f32 v207, v203, v203
    v_add_f32 v204, v204, v206
    v_add_f32 v205, v205, v207
    s_nop 0
    v_mfma_f32_32x32x16_bf16 v[32:47], v[96:99], v[108:111], v[32:47]
    ds_read_b64_tr_b16 v[92:93], v125 offset:8192
    ds_read_b64_tr_b16 v[94:95], v125 offset:9216
    ds_read_b128 v[84:87], v118 offset:20480
    v_add_f32_dpp v204, v204, v204 row_shr:1 row_mask:0xf bank_mask:0xf bound_ctrl:0
    v_add_f32_dpp v205, v205, v205 row_shr:1 row_mask:0xf bank_mask:0xf bound_ctrl:0
    s_nop 0
    v_add_f32_dpp v204, v204, v204 row_shr:2 row_mask:0xf bank_mask:0xf bound_ctrl:0
    v_add_f32_dpp v205, v205, v205 row_shr:2 row_mask:0xf bank_mask:0xf bound_ctrl:0
    v_mfma_f32_32x32x16_bf16 v[48:63], v[100:103], v[104:107], v[48:63]
    s_nop 0
    v_add_f32_dpp v204, v204, v204 row_shr:4 row_mask:0xf bank_mask:0xf bound_ctrl:0
    v_add_f32_dpp v205, v205, v205 row_shr:4 row_mask:0xf bank_mask:0xf bound_ctrl:0
    s_nop 0
    v_add_f32_dpp v204, v204, v204 row_shr:8 row_mask:0xf bank_mask:0xf bound_ctrl:0
    s_cbranch_vccnz L_sk48
    s_mov_b32 m0, s57
    s_mov_b32 s53, 196608
    buffer_load_dwordx4 v164, s[12:15], s53 offen lds
    s_add_u32 m0, s57, 8192
    s_nop 0
    buffer_load_dwordx4 v164, s[16:19], s53 offen lds
L_sk48:
    v_mfma_f32_32x32x16_bf16 v[64:79], v[100:103], v[108:111], v[64:79]
    v_add_f32_dpp v205, v205, v205 row_shr:8 row_mask:0xf bank_mask:0xf bound_ctrl:0
    s_nop 0
    v_add_f32_dpp v204, v204, v204 row_bcast:15 row_mask:0xa bank_mask:0xf
    v_add_f32_dpp v205, v205, v205 row_bcast:15 row_mask:0xa bank_mask:0xf
    s_nop 0
    s_cbranch_vccnz L_sk49
    s_add_u32 m0, s57, 4096
    s_nop 0
    buffer_load_dwordx4 v165, s[12:15], s53 offen lds
    s_add_u32 m0, s57, 12288
    s_nop 0
    buffer_load_dwordx4 v165, s[16:19], s53 offen lds
L_sk49:
    s_waitcnt lgkmcnt(3)
    v_mfma_f32_32x32x16_bf16 v[16:31], v[80:83], v[88:91], v[16:31]
    ds_read_b128 v[96:99], v119 offset:16384
    ds_read_b64_tr_b16 v[104:105], v125 offset:4096
    ds_read_b64_tr_b16 v[106:107], v125 offset:5120
    v_add_f32_dpp v204, v204, v204 row_bcast:31 row_mask:0xc bank_mask:0xf
    v_add_f32_dpp v205, v205, v205 row_bcast:31 row_mask:0xc bank_mask:0xf
    v_mul_f32 v206, 0x3b000000, v204
    v_mul_f32 v207, 0x3b000000, v205
    v_fma_f32 v207, -v206, v206, v207
    s_waitcnt lgkmcnt(4)
    v_mfma_f32_32x32x16_bf16 v[32:47], v[80:83], v[92:95], v[32:47]
    ds_read_b64_tr_b16 v[108:109], v125 offset:12288
    ds_read_b64_tr_b16 v[110:111], v125 offset:13312
    ds_read_b128 v[100:103], v119 offset:20480
    v_max_f32 v207, 0, v207
    v_cvt_pk_bf16_f32 v208, v206, v207
    v_lshlrev_b32 v206, 16, v208
    v_and_b32 v207, s66, v208
    v_add_f32 v207, 0x3727c5ac, v207
    s_waitcnt lgkmcnt(6)
    v_mfma_f32_32x32x16_bf16 v[48:63], v[84:87], v[88:91], v[48:63]
    v_cvt_pk_bf16_f32 v208, v207, v207
    v_and_b32 v207, s66, v208
    v_sqrt_f32 v207, v207
    s_nop 0
    s_cbranch_vccnz L_sk50
    s_add_u32 m0, s57, 98304
    s_movk_i32 s56, 384
    buffer_load_dwordx4 v160, s[4:7], s56 offen lds
    s_add_u32 m0, s57, 102400
    s_nop 0
    buffer_load_dwordx4 v161, s[4:7], s56 offen lds
L_sk50:
    v_mfma_f32_32x32x16_bf16 v[64:79], v[84:87], v[92:95], v[64:79]
    v_cvt_pk_bf16_f32 v208, v207, v207
    v_and_b32 v207, s66, v208
    v_lshrrev_b32 v206, 16, v206
    v_or_b32 v146, v206, v207
    s_cbranch_vccnz L_sk51
    s_add_u32 m0, s57, 106496
    s_nop 0
    buffer_load_dwordx4 v162, s[4:7], s56 offen lds
    s_add_u32 m0, s57, 110592
    s_nop 0
    buffer_load_dwordx4 v163, s[4:7], s56 offen lds
L_sk51:
    s_waitcnt lgkmcnt(3)
    v_mfma_f32_32x32x16_bf16 v[16:31], v[96:99], v[104:107], v[16:31]
    s_waitcnt vmcnt(12) lgkmcnt(0)
    s_barrier
    ds_read_b128 v[80:83], v116 offset:32768
    ds_read_b64_tr_b16 v[88:89], v125 offset:16384
    ds_read_b64_tr_b16 v[90:91], v125 offset:17408
    v_mfma_f32_32x32x16_bf16 v[32:47], v[96:99], v[108:111], v[32:47]
    ds_read_b64_tr_b16 v[92:93], v125 offset:24576
    ds_read_b64_tr_b16 v[94:95], v125 offset:25600
    ds_read_b128 v[84:87], v116 offset:36864
    s_cbranch_vccz L_hw52
    s_waitcnt vmcnt(0)
L_hw52:
    v_readfirstlane_b32 s61, v14
    s_cmp_eq_u32 s61, 0
    s_cbranch_scc1 L_ns54
L_nb53:
    v_readfirstlane_b32 s34, v14
    v_readfirstlane_b32 s35, v15
    v_mov_b32 v147, v14
    s_lshl_b32 s64, s50, 3
    s_add_u32 s72, s72, s64
    s_mov_b32 exec_lo, 0
    s_mov_b32 exec_hi, 0x80000000
    buffer_store_dwordx2 v[146:147], v166, s[20:23], s72 offen sc1
    s_mov_b64 exec, -1
    v_mfma_f32_32x32x16_bf16 v[48:63], v[100:103], v[104:107], v[48:63]
    s_cbranch_vccnz L_sk56
    s_add_u32 m0, s57, 16384
    s_mov_b32 s53, 229376
    buffer_load_dwordx4 v164, s[12:15], s53 offen lds
    s_add_u32 m0, s57, 24576
    s_nop 0
    buffer_load_dwordx4 v164, s[16:19], s53 offen lds
L_sk56:
    v_mfma_f32_32x32x16_bf16 v[64:79], v[100:103], v[108:111], v[64:79]
    s_cbranch_vccnz L_sk57
    s_add_u32 m0, s57, 20480
    s_nop 0
    buffer_load_dwordx4 v165, s[12:15], s53 offen lds
    s_add_u32 m0, s57, 28672
    s_nop 0
    buffer_load_dwordx4 v165, s[16:19], s53 offen lds
L_sk57:
    s_waitcnt lgkmcnt(3)
    v_mfma_f32_32x32x16_bf16 v[16:31], v[80:83], v[88:91], v[16:31]
    ds_read_b128 v[96:99], v117 offset:32768
    ds_read_b64_tr_b16 v[104:105], v125 offset:20480
    ds_read_b64_tr_b16 v[106:107], v125 offset:21504
    s_mov_b32 s3, 7
    s_lshl_b32 s64, s50, 9
    s_add_u32 s64, s64, 155648
    v_lshlrev_b32 v5, 2, v1
    v_add_u32 v126, s64, v5
    s_waitcnt lgkmcnt(4)
    v_mfma_f32_32x32x16_bf16 v[32:47], v[80:83], v[92:95], v[32:47]
    ds_read_b64_tr_b16 v[108:109], v125 offset:28672
    ds_read_b64_tr_b16 v[110:111], v125 offset:29696
    ds_read_b128 v[100:103], v117 offset:36864
    v_lshlrev_b32 v5, 4, v2
    v_add_u32 v127, s64, v5
    v_and_b32 v4, 1, v1
    v_bfe_u32 v5, v1, 2, 1
    v_lshl_add_u32 v4, v5, 1, v4
    s_waitcnt lgkmcnt(6)
    v_mfma_f32_32x32x16_bf16 v[48:63], v[84:87], v[88:91], v[48:63]
    v_lshlrev_b32 v4, 12, v4
    v_bfe_u32 v5, v1, 1, 1
    v_lshl_add_u32 v4, v5, 7, v4
    v_bfe_u32 v5, v1, 3, 3
    v_lshl_add_u32 v4, v5, 8, v4
    s_cbranch_vccnz L_sk58
    s_add_u32 m0, s57, 32768
    s_mov_b32 s53, 262144
    buffer_load_dwordx4 v164, s[12:15], s53 offen lds
    s_add_u32 m0, s57, 40960
    s_nop 0
    buffer_load_dwordx4 v164, s[16:19], s53 offen lds
L_sk58:
    v_mfma_f32_32x32x16_bf16 v[64:79], v[84:87], v[92:95], v[64:79]
    s_and_b32 s65, s48, 1
    s_lshl_b32 s71, s62, 3
    s_add_u32 s65, s65, s71
    s_lshl_b32 s65, s65, 11
    s_lshr_b32 s71, s48, 1
    s_cbranch_vccnz L_sk59
    s_add_u32 m0, s57, 36864
    s_nop 0
    buffer_load_dwordx4 v165, s[12:15], s53 offen lds
    s_add_u32 m0, s57, 45056
    s_nop 0
    buffer_load_dwordx4 v165, s[16:19], s53 offen lds
L_sk59:
    s_waitcnt lgkmcnt(3)
    v_mfma_f32_32x32x16_bf16 v[16:31], v[96:99], v[104:107], v[16:31]
    s_waitcnt vmcnt(17) lgkmcnt(0)
    s_barrier
    ds_read_b128 v[80:83], v118 offset:32768
    ds_read_b64_tr_b16 v[88:89], v125 offset:32768
    ds_read_b64_tr_b16 v[90:91], v125 offset:33792
    s_lshl_b32 s71, s71, 3
    s_add_u32 s65, s65, s71
    s_add_u32 s65, s65, 9510912
    v_add_u32 v171, s65, v4
    v_lshlrev_b32 v4, 20, v2
    v_mfma_f32_32x32x16_bf16 v[32:47], v[96:99], v[108:111], v[32:47]
    ds_read_b64_tr_b16 v[92:93], v125 offset:40960
    ds_read_b64_tr_b16 v[94:95], v125 offset:41984
    ds_read_b128 v[84:87], v118 offset:36864
    v_lshl_add_u32 v4, v3, 4, v4
    s_lshl_b32 s54, s48, 13
    s_sub_u32 s65, s49, 14
    s_lshl_b32 s65, s65, 11
    s_add_u32 s54, s54, s65
    v_mfma_f32_32x32x16_bf16 v[48:63], v[100:103], v[104:107], v[48:63]
    s_lshl_b32 s65, s63, 9
    s_add_u32 s54, s54, s65
    s_lshl_b32 s65, s62, 12
    s_add_u32 s54, s54, s65
    s_add_u32 s54, s54, 7340032
    s_cbranch_vccnz L_sk60
    s_add_u32 m0, s57, 114688
    s_movk_i32 s56, 512
    buffer_load_dwordx4 v160, s[4:7], s56 offen lds
    s_add_u32 m0, s57, 118784
    s_nop 0
    buffer_load_dwordx4 v161, s[4:7], s56 offen lds
L_sk60:
    v_mfma_f32_32x32x16_bf16 v[64:79], v[100:103], v[108:111], v[64:79]
    s_mov_b32 s74, 0x3f6c835e
    s_mov_b32 s76, 0x3ec3ef15
    s_cbranch_vccnz L_sk61
    s_add_u32 m0, s57, 122880
    s_nop 0
    buffer_load_dwordx4 v162, s[4:7], s56 offen lds
    s_add_u32 m0, s57, 126976
    s_nop 0
    buffer_load_dwordx4 v163, s[4:7], s56 offen lds
L_sk61:
    s_waitcnt lgkmcnt(3)
    v_mfma_f32_32x32x16_bf16 v[16:31], v[80:83], v[88:91], v[16:31]
    ds_read_b128 v[96:99], v119 offset:32768
    ds_read_b64_tr_b16 v[104:105], v125 offset:36864
    ds_read_b64_tr_b16 v[106:107], v125 offset:37888
    s_waitcnt lgkmcnt(4)
    v_mfma_f32_32x32x16_bf16 v[32:47], v[80:83], v[92:95], v[32:47]
    ds_read_b64_tr_b16 v[108:109], v125 offset:45056
    ds_read_b64_tr_b16 v[110:111], v125 offset:46080
    ds_read_b128 v[100:103], v119 offset:36864
    s_waitcnt lgkmcnt(6)
    v_mfma_f32_32x32x16_bf16 v[48:63], v[84:87], v[88:91], v[48:63]
    s_cbranch_vccnz L_sk62
    s_add_u32 m0, s57, 49152
    s_mov_b32 s53, 294912
    buffer_load_dwordx4 v164, s[12:15], s53 offen lds
    s_add_u32 m0, s57, 57344
    s_nop 0
    buffer_load_dwordx4 v164, s[16:19], s53 offen lds
L_sk62:
    v_mfma_f32_32x32x16_bf16 v[64:79], v[84:87], v[92:95], v[64:79]
    s_cbranch_vccnz L_sk63
    s_add_u32 m0, s57, 53248
    s_nop 0
    buffer_load_dwordx4 v165, s[12:15], s53 offen lds
    s_add_u32 m0, s57, 61440
    s_nop 0
    buffer_load_dwordx4 v165, s[16:19], s53 offen lds
L_sk63:
    s_waitcnt lgkmcnt(3)
    v_mfma_f32_32x32x16_bf16 v[16:31], v[96:99], v[104:107], v[16:31]
    s_waitcnt vmcnt(17) lgkmcnt(0)
    s_barrier
    ds_read_b128 v[80:83], v116 offset:0
    ds_read_b64_tr_b16 v[88:89], v124 offset:0
    ds_read_b64_tr_b16 v[90:91], v124 offset:1024
    v_mfma_f32_32x32x16_bf16 v[32:47], v[96:99], v[108:111], v[32:47]
    ds_read_b64_tr_b16 v[92:93], v124 offset:8192
    ds_read_b64_tr_b16 v[94:95], v124 offset:9216
    ds_read_b128 v[84:87], v116 offset:4096
    v_mfma_f32_32x32x16_bf16 v[48:63], v[100:103], v[104:107], v[48:63]
    s_cbranch_vccnz L_sk64
    s_add_u32 m0, s57, 65536
    s_mov_b32 s53, 327680
    buffer_load_dwordx4 v164, s[12:15], s53 offen lds
    s_add_u32 m0, s57, 73728
    s_nop 0
    buffer_load_dwordx4 v164, s[16:19], s53 offen lds
L_sk64:
    v_mfma_f32_32x32x16_bf16 v[64:79], v[100:103], v[108:111], v[64:79]
    s_cbranch_vccnz L_sk65
    s_add_u32 m0, s57, 69632
    s_nop 0
    buffer_load_dwordx4 v165, s[12:15], s53 offen lds
    s_add_u32 m0, s57, 77824
    s_nop 0
    buffer_load_dwordx4 v165, s[16:19], s53 offen lds
L_sk65:
    s_waitcnt lgkmcnt(3)
    v_mfma_f32_32x32x16_bf16 v[16:31], v[80:83], v[88:91], v[16:31]
    ds_read_b128 v[96:99], v117 offset:0
    ds_read_b64_tr_b16 v[104:105], v124 offset:4096
    ds_read_b64_tr_b16 v[106:107], v124 offset:5120
    s_waitcnt lgkmcnt(4)
    v_mfma_f32_32x32x16_bf16 v[32:47], v[80:83], v[92:95], v[32:47]
    ds_read_b64_tr_b16 v[108:109], v124 offset:12288
    ds_read_b64_tr_b16 v[110:111], v124 offset:13312
    ds_read_b128 v[100:103], v117 offset:4096
    s_waitcnt lgkmcnt(6)
    v_mfma_f32_32x32x16_bf16 v[48:63], v[84:87], v[88:91], v[48:63]
    s_cbranch_vccnz L_sk66
    s_add_u32 m0, s57, 131072
    s_movk_i32 s56, 640
    buffer_load_dwordx4 v160, s[4:7], s56 offen lds
    s_add_u32 m0, s57, 135168
    s_nop 0
    buffer_load_dwordx4 v161, s[4:7], s56 offen lds
L_sk66:
    v_mfma_f32_32x32x16_bf16 v[64:79], v[84:87], v[92:95], v[64:79]
    s_cbranch_vccnz L_sk67
    s_add_u32 m0, s57, 139264
    s_nop 0
    buffer_load_dwordx4 v162, s[4:7], s56 offen lds
    s_add_u32 m0, s57, 143360
    s_nop 0
    buffer_load_dwordx4 v163, s[4:7], s56 offen lds
L_sk67:
    s_waitcnt lgkmcnt(3)
    v_mfma_f32_32x32x16_bf16 v[16:31], v[96:99], v[104:107], v[16:31]
    s_waitcnt vmcnt(20) lgkmcnt(0)
    s_barrier
    ds_read_b128 v[80:83], v118 offset:0
    ds_read_b64_tr_b16 v[88:89], v124 offset:16384
    ds_read_b64_tr_b16 v[90:91], v124 offset:17408
    v_mfma_f32_32x32x16_bf16 v[32:47], v[96:99], v[108:111], v[32:47]
    ds_read_b64_tr_b16 v[92:93], v124 offset:24576
    ds_read_b64_tr_b16 v[94:95], v124 offset:25600
    ds_read_b128 v[84:87], v118 offset:4096
    v_mfma_f32_32x32x16_bf16 v[48:63], v[100:103], v[104:107], v[48:63]
    s_cbranch_vccnz L_sk68
    s_add_u32 m0, s57, 81920
    s_mov_b32 s53, 360448
    buffer_load_dwordx4 v164, s[12:15], s53 offen lds
    s_add_u32 m0, s57, 90112
    s_nop 0
    buffer_load_dwordx4 v164, s[16:19], s53 offen lds
L_sk68:
    v_mfma_f32_32x32x16_bf16 v[64:79], v[100:103], v[108:111], v[64:79]
    s_cbranch_vccnz L_sk69
    s_add_u32 m0, s57, 86016
    s_nop 0
    buffer_load_dwordx4 v165, s[12:15], s53 offen lds
    s_add_u32 m0, s57, 94208
    s_nop 0
    buffer_load_dwordx4 v165, s[16:19], s53 offen lds
L_sk69:
    s_waitcnt lgkmcnt(3)
    v_mfma_f32_32x32x16_bf16 v[16:31], v[80:83], v[88:91], v[16:31]
    ds_read_b128 v[96:99], v119 offset:0
    ds_read_b64_tr_b16 v[104:105], v124 offset:20480
    ds_read_b64_tr_b16 v[106:107], v124 offset:21504
    s_waitcnt lgkmcnt(4)
    v_mfma_f32_32x32x16_bf16 v[32:47], v[80:83], v[92:95], v[32:47]
    ds_read_b64_tr_b16 v[108:109], v124 offset:28672
    ds_read_b64_tr_b16 v[110:111], v124 offset:29696
    ds_read_b128 v[100:103], v119 offset:4096
    s_waitcnt lgkmcnt(6)
    v_mfma_f32_32x32x16_bf16 v[48:63], v[84:87], v[88:91], v[48:63]
    s_cbranch_vccnz L_sk70
    s_mov_b32 m0, s57
    s_mov_b32 s53, 393216
    buffer_load_dwordx4 v164, s[12:15], s53 offen lds
    s_add_u32 m0, s57, 8192
    s_nop 0
    buffer_load_dwordx4 v164, s[16:19], s53 offen lds
L_sk70:
    v_mfma_f32_32x32x16_bf16 v[64:79], v[84:87], v[92:95], v[64:79]
    s_cbranch_vccnz L_sk71
    s_add_u32 m0, s57, 4096
    s_nop 0
    buffer_load_dwordx4 v165, s[12:15], s53 offen lds
    s_add_u32 m0, s57, 12288
    s_nop 0
    buffer_load_dwordx4 v165, s[16:19], s53 offen lds
L_sk71:
    s_waitcnt lgkmcnt(3)
    v_mfma_f32_32x32x16_bf16 v[16:31], v[96:99], v[104:107], v[16:31]
    s_waitcnt vmcnt(20) lgkmcnt(0)
    s_barrier
    ds_read_b128 v[80:83], v116 offset:16384
    ds_read_b64_tr_b16 v[88:89], v124 offset:32768
    ds_read_b64_tr_b16 v[90:91], v124 offset:33792
    v_mfma_f32_32x32x16_bf16 v[32:47], v[96:99], v[108:111], v[32:47]
    ds_read_b64_tr_b16 v[92:93], v124 offset:40960
    ds_read_b64_tr_b16 v[94:95], v124 offset:41984
    ds_read_b128 v[84:87], v116 offset:20480
    v_mfma_f32_32x32x16_bf16 v[48:63], v[100:103], v[104:107], v[48:63]
    s_cbranch_vccnz L_sk72
    s_add_u32 m0, s57, 98304
    s_movk_i32 s56, 768
    buffer_load_dwordx4 v160, s[4:7], s56 offen lds
    s_add_u32 m0, s57, 102400
    s_nop 0
    buffer_load_dwordx4 v161, s[4:7], s56 offen lds
L_sk72:
    v_mfma_f32_32x32x16_bf16 v[64:79], v[100:103], v[108:111], v[64:79]
    s_cbranch_vccnz L_sk73
    s_add_u32 m0, s57, 106496
    s_nop 0
    buffer_load_dwordx4 v162, s[4:7], s56 offen lds
    s_add_u32 m0, s57, 110592
    s_nop 0
    buffer_load_dwordx4 v163, s[4:7], s56 offen lds
L_sk73:
    s_waitcnt lgkmcnt(3)
    v_mfma_f32_32x32x16_bf16 v[16:31], v[80:83], v[88:91], v[16:31]
    ds_read_b128 v[96:99], v117 offset:16384
    ds_read_b64_tr_b16 v[104:105], v124 offset:36864
    ds_read_b64_tr_b16 v[106:107], v124 offset:37888
    s_waitcnt lgkmcnt(4)
    v_mfma_f32_32x32x16_bf16 v[32:47], v[80:83], v[92:95], v[32:47]
    ds_read_b64_tr_b16 v[108:109], v124 offset:45056
    ds_read_b64_tr_b16 v[110:111], v124 offset:46080
    ds_read_b128 v[100:103], v117 offset:20480
    s_waitcnt lgkmcnt(6)
    v_mfma_f32_32x32x16_bf16 v[48:63], v[84:87], v[88:91], v[48:63]
    s_cbranch_vccnz L_sk74
    s_add_u32 m0, s57, 16384
    s_mov_b32 s53, 425984
    buffer_load_dwordx4 v164, s[12:15], s53 offen lds
    s_add_u32 m0, s57, 24576
    s_nop 0
    buffer_load_dwordx4 v164, s[16:19], s53 offen lds
L_sk74:
    v_mfma_f32_32x32x16_bf16 v[64:79], v[84:87], v[92:95], v[64:79]
    s_cbranch_vccnz L_sk75
    s_add_u32 m0, s57, 20480
    s_nop 0
    buffer_load_dwordx4 v165, s[12:15], s53 offen lds
    s_add_u32 m0, s57, 28672
    s_nop 0
    buffer_load_dwordx4 v165, s[16:19], s53 offen lds
L_sk75:
    s_waitcnt lgkmcnt(3)
    v_mfma_f32_32x32x16_bf16 v[16:31], v[96:99], v[104:107], v[16:31]
    s_waitcnt vmcnt(24) lgkmcnt(0)
    s_barrier
    ds_read_b128 v[80:83], v118 offset:16384
    ds_read_b64_tr_b16 v[88:89], v125 offset:0
    ds_read_b64_tr_b16 v[90:91], v125 offset:1024
    v_mfma_f32_32x32x16_bf16 v[32:47], v[96:99], v[108:111], v[32:47]
    ds_read_b64_tr_b16 v[92:93], v125 offset:8192
    ds_read_b64_tr_b16 v[94:95], v125 offset:9216
    ds_read_b128 v[84:87], v118 offset:20480
    buffer_load_dwordx2 v[146:147], v171, s[20:23], 0 offen sc1
    v_mfma_f32_32x32x16_bf16 v[48:63], v[100:103], v[104:107], v[48:63]
    s_cbranch_vccnz L_sk76
    s_add_u32 m0, s57, 32768
    s_mov_b32 s53, 458752
    buffer_load_dwordx4 v164, s[12:15], s53 offen lds
    s_add_u32 m0, s57, 40960
    s_nop 0
    buffer_load_dwordx4 v164, s[16:19], s53 offen lds
L_sk76:
    v_mfma_f32_32x32x16_bf16 v[64:79], v[100:103], v[108:111], v[64:79]
    s_cbranch_vccnz L_sk77
    s_add_u32 m0, s57, 36864
    s_nop 0
    buffer_load_dwordx4 v165, s[12:15], s53 offen lds
    s_add_u32 m0, s57, 45056
    s_nop 0
    buffer_load_dwordx4 v165, s[16:19], s53 offen lds
L_sk77:
    s_waitcnt lgkmcnt(3)
    v_mfma_f32_32x32x16_bf16 v[16:31], v[80:83], v[88:91], v[16:31]
    ds_read_b128 v[96:99], v119 offset:16384
    ds_read_b64_tr_b16 v[104:105], v125 offset:4096
    ds_read_b64_tr_b16 v[106:107], v125 offset:5120
    s_waitcnt lgkmcnt(4)
    v_mfma_f32_32x32x16_bf16 v[32:47], v[80:83], v[92:95], v[32:47]
    ds_read_b64_tr_b16 v[108:109], v125 offset:12288
    ds_read_b64_tr_b16 v[110:111], v125 offset:13312
    ds_read_b128 v[100:103], v119 offset:20480
    s_waitcnt lgkmcnt(6)
    v_mfma_f32_32x32x16_bf16 v[48:63], v[84:87], v[88:91], v[48:63]
    v_mfma_f32_32x32x16_bf16 v[64:79], v[84:87], v[92:95], v[64:79]
    s_waitcnt lgkmcnt(3)
    v_mfma_f32_32x32x16_bf16 v[16:31], v[96:99], v[104:107], v[16:31]
    s_waitcnt vmcnt(4) lgkmcnt(0)
    s_barrier
    ds_read_b128 v[80:83], v116 offset:32768
    ds_read_b64_tr_b16 v[88:89], v125 offset:16384
    ds_read_b64_tr_b16 v[90:91], v125 offset:17408
    v_mfma_f32_32x32x16_bf16 v[32:47], v[96:99], v[108:111], v[32:47]
    ds_read_b64_tr_b16 v[92:93], v125 offset:24576
    ds_read_b64_tr_b16 v[94:95], v125 offset:25600
    ds_read_b128 v[84:87], v116 offset:36864
    v_mfma_f32_32x32x16_bf16 v[48:63], v[100:103], v[104:107], v[48:63]
    s_cbranch_vccnz L_sk78
    s_add_u32 m0, s57, 114688
    s_movk_i32 s56, 896
    buffer_load_dwordx4 v160, s[4:7], s56 offen lds
    s_add_u32 m0, s57, 118784
    s_nop 0
    buffer_load_dwordx4 v161, s[4:7], s56 offen lds
L_sk78:
    v_mfma_f32_32x32x16_bf16 v[64:79], v[100:103], v[108:111], v[64:79]
    s_cbranch_vccnz L_sk79
    s_add_u32 m0, s57, 122880
    s_nop 0
    buffer_load_dwordx4 v162, s[4:7], s56 offen lds
    s_add_u32 m0, s57, 126976
    s_nop 0
    buffer_load_dwordx4 v163, s[4:7], s56 offen lds
L_sk79:
    s_cbranch_vccz L_hw80
    s_waitcnt vmcnt(0)
L_hw80:
    v_cmp_ne_u32 s[78:79], v147, v14
    s_cmp_lg_u64 s[78:79], 0
    s_cbranch_scc1 L_ts82
L_tb81:
    v_and_b32 v5, s66, v146
    v_rcp_f32 v5, v5
    s_waitcnt lgkmcnt(3)
    v_mfma_f32_32x32x16_bf16 v[16:31], v[80:83], v[88:91], v[16:31]
    ds_read_b128 v[96:99], v117 offset:32768
    ds_read_b64_tr_b16 v[104:105], v125 offset:20480
    ds_read_b64_tr_b16 v[106:107], v125 offset:21504
    s_waitcnt lgkmcnt(4)
    v_mfma_f32_32x32x16_bf16 v[32:47], v[80:83], v[92:95], v[32:47]
    ds_read_b64_tr_b16 v[108:109], v125 offset:28672
    ds_read_b64_tr_b16 v[110:111], v125 offset:29696
    ds_read_b128 v[100:103], v117 offset:36864
    s_waitcnt lgkmcnt(6)
    v_mfma_f32_32x32x16_bf16 v[48:63], v[84:87], v[88:91], v[48:63]
    s_cbranch_vccnz L_sk84
    s_add_u32 m0, s57, 49152
    s_mov_b32 s53, 491520
    buffer_load_dwordx4 v164, s[12:15], s53 offen lds
    s_add_u32 m0, s57, 57344
    s_nop 0
    buffer_load_dwordx4 v164, s[16:19], s53 offen lds
L_sk84:
    v_mfma_f32_32x32x16_bf16 v[64:79], v[84:87], v[92:95], v[64:79]
    s_cbranch_vccnz L_sk85
    s_add_u32 m0, s57, 53248
    s_nop 0
    buffer_load_dwordx4 v165, s[12:15], s53 offen lds
    s_add_u32 m0, s57, 61440
    s_nop 0
    buffer_load_dwordx4 v165, s[16:19], s53 offen lds
L_sk85:
    s_waitcnt lgkmcnt(3)
    v_mfma_f32_32x32x16_bf16 v[16:31], v[96:99], v[104:107], v[16:31]
    ds_write_b32 v126, v5
    s_waitcnt vmcnt(25) lgkmcnt(0)
    s_barrier
    ds_read_b128 v[80:83], v118 offset:32768
    ds_read_b64_tr_b16 v[88:89], v125 offset:32768
    ds_read_b64_tr_b16 v[90:91], v125 offset:33792
    v_mfma_f32_32x32x16_bf16 v[32:47], v[96:99], v[108:111], v[32:47]
    ds_read_b64_tr_b16 v[92:93], v125 offset:40960
    ds_read_b64_tr_b16 v[94:95], v125 offset:41984
    ds_read_b128 v[84:87], v118 offset:36864
    buffer_load_dwordx2 v[190:191], v174, s[20:23], 0 offen sc1
    v_mfma_f32_32x32x16_bf16 v[48:63], v[100:103], v[104:107], v[48:63]
    v_mfma_f32_32x32x16_bf16 v[64:79], v[100:103], v[108:111], v[64:79]
    s_waitcnt lgkmcnt(3)
    v_mfma_f32_32x32x16_bf16 v[16:31], v[80:83], v[88:91], v[16:31]
    ds_read_b128 v[96:99], v119 offset:32768
    ds_read_b64_tr_b16 v[104:105], v125 offset:36864
    ds_read_b64_tr_b16 v[106:107], v125 offset:37888
    s_waitcnt lgkmcnt(4)
    v_mfma_f32_32x32x16_bf16 v[32:47], v[80:83], v[92:95], v[32:47]
    ds_read_b64_tr_b16 v[108:109], v125 offset:45056
    ds_read_b64_tr_b16 v[110:111], v125 offset:46080
    ds_read_b128 v[100:103], v119 offset:36864
    s_waitcnt lgkmcnt(6)
    v_mfma_f32_32x32x16_bf16 v[48:63], v[84:87], v[88:91], v[48:63]
    v_mfma_f32_32x32x16_bf16 v[64:79], v[84:87], v[92:95], v[64:79]
    s_waitcnt lgkmcnt(3)
    v_mfma_f32_32x32x16_bf16 v[16:31], v[96:99], v[104:107], v[16:31]
    ds_read_b128 v[128:131], v127 offset:0
    ds_read_b128 v[144:147], v127 offset:128
    ds_read_b128 v[132:135], v127 offset:32
    ds_read_b128 v[148:151], v127 offset:160
    ds_read_b128 v[136:139], v127 offset:64
    ds_read_b128 v[152:155], v127 offset:192
    ds_read_b128 v[140:143], v127 offset:96
    ds_read_b128 v[156:159], v127 offset:224
    s_waitcnt vmcnt(0) lgkmcnt(0)
    s_barrier
    ds_read_b128 v[80:83], v116 offset:0
    ds_read_b64_tr_b16 v[88:89], v124 offset:0
    ds_read_b64_tr_b16 v[90:91], v124 offset:1024
    v_mfma_f32_32x32x16_bf16 v[32:47], v[96:99], v[108:111], v[32:47]
    ds_read_b64_tr_b16 v[92:93], v124 offset:8192
    ds_read_b64_tr_b16 v[94:95], v124 offset:9216
    ds_read_b128 v[84:87], v116 offset:4096
    v_mfma_f32_32x32x16_bf16 v[48:63], v[100:103], v[104:107], v[48:63]
    v_mfma_f32_32x32x16_bf16 v[64:79], v[100:103], v[108:111], v[64:79]
    s_cmp_eq_u32 s50, 7
    s_cbranch_scc1 L_dq86
    s_cbranch_vccz L_hw87
    s_waitcnt vmcnt(0)
L_hw87:
    v_cmp_ne_u64 s[78:79], v[190:191], v[14:15]
    s_cmp_lg_u64 s[78:79], 0
    s_cbranch_scc1 L_ts89
L_tb88:
L_dq86:
    s_waitcnt lgkmcnt(3)
    v_mfma_f32_32x32x16_bf16 v[16:31], v[80:83], v[88:91], v[16:31]
    ds_read_b128 v[96:99], v117 offset:0
    ds_read_b64_tr_b16 v[104:105], v124 offset:4096
    ds_read_b64_tr_b16 v[106:107], v124 offset:5120
    s_waitcnt lgkmcnt(4)
    v_mfma_f32_32x32x16_bf16 v[32:47], v[80:83], v[92:95], v[32:47]
    ds_read_b64_tr_b16 v[108:109], v124 offset:12288
    ds_read_b64_tr_b16 v[110:111], v124 offset:13312
    ds_read_b128 v[100:103], v117 offset:4096
    s_waitcnt lgkmcnt(6)
    v_mfma_f32_32x32x16_bf16 v[48:63], v[84:87], v[88:91], v[48:63]
    buffer_load_dwordx4 v[192:195], v6, s[20:23], s51 offen offset:0 sc1
    v_mfma_f32_32x32x16_bf16 v[64:79], v[84:87], v[92:95], v[64:79]
    buffer_load_dwordx4 v[196:199], v6, s[20:23], s51 offen offset:1024 sc1
    s_waitcnt lgkmcnt(3)
    v_mfma_f32_32x32x16_bf16 v[16:31], v[96:99], v[104:107], v[16:31]
    s_waitcnt vmcnt(16) lgkmcnt(0)
    s_barrier
    ds_read_b128 v[80:83], v118 offset:0
    ds_read_b64_tr_b16 v[88:89], v124 offset:16384
    ds_read_b64_tr_b16 v[90:91], v124 offset:17408
    v_mfma_f32_32x32x16_bf16 v[32:47], v[96:99], v[108:111], v[32:47]
    ds_read_b64_tr_b16 v[92:93], v124 offset:24576
    ds_read_b64_tr_b16 v[94:95], v124 offset:25600
    ds_read_b128 v[84:87], v118 offset:4096
    v_mfma_f32_32x32x16_bf16 v[48:63], v[100:103], v[104:107], v[48:63]
    buffer_load_dwordx4 v[200:203], v6, s[20:23], s51 offen offset:2048 sc1
    v_mfma_f32_32x32x16_bf16 v[64:79], v[100:103], v[108:111], v[64:79]
    buffer_load_dwordx4 v[204:207], v6, s[20:23], s51 offen offset:3072 sc1
    s_add_u32 s51, s51, 4096
    s_waitcnt lgkmcnt(3)
    v_mfma_f32_32x32x16_bf16 v[16:31], v[80:83], v[88:91], v[16:31]
    ds_read_b128 v[96:99], v119 offset:0
    ds_read_b64_tr_b16 v[104:105], v124 offset:20480
    ds_read_b64_tr_b16 v[106:107], v124 offset:21504
    s_waitcnt lgkmcnt(4)
    v_mfma_f32_32x32x16_bf16 v[32:47], v[80:83], v[92:95], v[32:47]
    ds_read_b64_tr_b16 v[108:109], v124 offset:28672
    ds_read_b64_tr_b16 v[110:111], v124 offset:29696
    ds_read_b128 v[100:103], v119 offset:4096
    s_waitcnt lgkmcnt(6)
    v_mfma_f32_32x32x16_bf16 v[48:63], v[84:87], v[88:91], v[48:63]
    buffer_load_dwordx4 v[208:211], v6, s[20:23], s51 offen offset:0 sc1
    v_mfma_f32_32x32x16_bf16 v[64:79], v[84:87], v[92:95], v[64:79]
    buffer_load_dwordx4 v[212:215], v6, s[20:23], s51 offen offset:1024 sc1
    s_waitcnt lgkmcnt(3)
    v_mfma_f32_32x32x16_bf16 v[16:31], v[96:99], v[104:107], v[16:31]
    s_waitcnt vmcnt(11) lgkmcnt(0)
    s_barrier
    ds_read_b128 v[80:83], v116 offset:16384
    ds_read_b64_tr_b16 v[88:89], v124 offset:32768
    ds_read_b64_tr_b16 v[90:91], v124 offset:33792
    v_mfma_f32_32x32x16_bf16 v[32:47], v[96:99], v[108:111], v[32:47]
    ds_read_b64_tr_b16 v[92:93], v124 offset:40960
    ds_read_b64_tr_b16 v[94:95], v124 offset:41984
    ds_read_b128 v[84:87], v116 offset:20480
    v_mfma_f32_32x32x16_bf16 v[48:63], v[100:103], v[104:107], v[48:63]
    buffer_load_dwordx4 v[216:219], v6, s[20:23], s51 offen offset:2048 sc1
    v_mfma_f32_32x32x16_bf16 v[64:79], v[100:103], v[108:111], v[64:79]
    buffer_load_dwordx4 v[220:223], v6, s[20:23], s51 offen offset:3072 sc1
    s_add_u32 s51, s51, 4096
    s_waitcnt lgkmcnt(3)
    v_mfma_f32_32x32x16_bf16 v[16:31], v[80:83], v[88:91], v[16:31]
    ds_read_b128 v[96:99], v117 offset:16384
    ds_read_b64_tr_b16 v[104:105], v124 offset:36864
    ds_read_b64_tr_b16 v[106:107], v124 offset:37888
    s_waitcnt lgkmcnt(4)
    v_mfma_f32_32x32x16_bf16 v[32:47], v[80:83], v[92:95], v[32:47]
    ds_read_b64_tr_b16 v[108:109], v124 offset:45056
    ds_read_b64_tr_b16 v[110:111], v124 offset:46080
    ds_read_b128 v[100:103], v117 offset:20480
    s_waitcnt lgkmcnt(6)
    v_mfma_f32_32x32x16_bf16 v[48:63], v[84:87], v[88:91], v[48:63]
    buffer_load_dwordx4 v[224:227], v6, s[20:23], s51 offen offset:0 sc1
    v_mfma_f32_32x32x16_bf16 v[64:79], v[84:87], v[92:95], v[64:79]
    buffer_load_dwordx4 v[228:231], v6, s[20:23], s51 offen offset:1024 sc1
    s_waitcnt lgkmcnt(3)
    v_mfma_f32_32x32x16_bf16 v[16:31], v[96:99], v[104:107], v[16:31]
    s_waitcnt vmcnt(11) lgkmcnt(0)
    s_barrier
    ds_read_b128 v[80:83], v118 offset:16384
    ds_read_b64_tr_b16 v[88:89], v125 offset:0
    ds_read_b64_tr_b16 v[90:91], v125 offset:1024
    v_mfma_f32_32x32x16_bf16 v[32:47], v[96:99], v[108:111], v[32:47]
    ds_read_b64_tr_b16 v[92:93], v125 offset:8192
    ds_read_b64_tr_b16 v[94:95], v125 offset:9216
    ds_read_b128 v[84:87], v118 offset:20480
    v_mfma_f32_32x32x16_bf16 v[48:63], v[100:103], v[104:107], v[48:63]
    buffer_load_dwordx4 v[232:235], v6, s[20:23], s51 offen offset:2048 sc1
    v_mfma_f32_32x32x16_bf16 v[64:79], v[100:103], v[108:111], v[64:79]
    buffer_load_dwordx4 v[236:239], v6, s[20:23], s51 offen offset:3072 sc1
    s_add_u32 s51, s51, 4096
    s_waitcnt lgkmcnt(3)
    v_mfma_f32_32x32x16_bf16 v[16:31], v[80:83], v[88:91], v[16:31]
    ds_read_b128 v[96:99], v119 offset:16384
    ds_read_b64_tr_b16 v[104:105], v125 offset:4096
    ds_read_b64_tr_b16 v[106:107], v125 offset:5120
    s_waitcnt lgkmcnt(4)
    v_mfma_f32_32x32x16_bf16 v[32:47], v[80:83], v[92:95], v[32:47]
    ds_read_b64_tr_b16 v[108:109], v125 offset:12288
    ds_read_b64_tr_b16 v[110:111], v125 offset:13312
    ds_read_b128 v[100:103], v119 offset:20480
    s_waitcnt lgkmcnt(6)
    v_mfma_f32_32x32x16_bf16 v[48:63], v[84:87], v[88:91], v[48:63]
    buffer_load_dwordx4 v[240:243], v6, s[20:23], s51 offen offset:0 sc1
    v_mfma_f32_32x32x16_bf16 v[64:79], v[84:87], v[92:95], v[64:79]
    buffer_load_dwordx4 v[244:247], v6, s[20:23], s51 offen offset:1024 sc1
    s_waitcnt lgkmcnt(3)
    v_mfma_f32_32x32x16_bf16 v[16:31], v[96:99], v[104:107], v[16:31]
    s_waitcnt lgkmcnt(0)
    s_barrier
    v_mfma_f32_32x32x16_bf16 v[32:47], v[96:99], v[108:111], v[32:47]
    v_mfma_f32_32x32x16_bf16 v[48:63], v[100:103], v[104:107], v[48:63]
    buffer_load_dwordx4 v[248:251], v6, s[20:23], s51 offen offset:2048 sc1
    v_mfma_f32_32x32x16_bf16 v[64:79], v[100:103], v[108:111], v[64:79]
    buffer_load_dwordx4 v[252:255], v6, s[20:23], s51 offen offset:3072 sc1
    s_add_u32 s51, s51, 4096
    s_setprio 1
    s_mov_b32 s78, 0x3f3504f3
    s_nop 9
    v_pk_mul_f32 v[16:17], v[16:17], v[128:129]
    v_pk_mul_f32 v[32:33], v[32:33], v[128:129]
    v_pk_mul_f32 v[18:19], v[18:19], v[130:131]
    v_pk_mul_f32 v[34:35], v[34:35], v[130:131]
    v_pk_mul_f32 v[20:21], v[20:21], v[132:133]
    v_pk_mul_f32 v[36:37], v[36:37], v[132:133]
    v_pk_mul_f32 v[22:23], v[22:23], v[134:135]
    v_pk_mul_f32 v[38:39], v[38:39], v[134:135]
    v_pk_fma_f32 v[110:111], v[48:49], v[144:145], v[16:17] neg_lo:[1,0,0] neg_hi:[1,0,0]
    v_pk_fma_f32 v[108:109], v[64:65], v[144:145], v[32:33] neg_lo:[1,0,0] neg_hi:[1,0,0]
    v_pk_fma_f32 v[106:107], v[50:51], v[146:147], v[18:19] neg_lo:[1,0,0] neg_hi:[1,0,0]
    v_pk_fma_f32 v[104:105], v[66:67], v[146:147], v[34:35] neg_lo:[1,0,0] neg_hi:[1,0,0]
    v_pk_fma_f32 v[102:103], v[52:53], v[148:149], v[20:21] neg_lo:[1,0,0] neg_hi:[1,0,0]
    v_pk_fma_f32 v[100:101], v[68:69], v[148:149], v[36:37] neg_lo:[1,0,0] neg_hi:[1,0,0]
    v_pk_fma_f32 v[98:99], v[54:55], v[150:151], v[22:23] neg_lo:[1,0,0] neg_hi:[1,0,0]
    v_pk_fma_f32 v[96:97], v[70:71], v[150:151], v[38:39] neg_lo:[1,0,0] neg_hi:[1,0,0]
    v_pk_fma_f32 v[16:17], v[48:49], v[144:145], v[16:17]
    v_pk_fma_f32 v[32:33], v[64:65], v[144:145], v[32:33]
    v_pk_fma_f32 v[18:19], v[50:51], v[146:147], v[18:19]
    v_pk_fma_f32 v[34:35], v[66:67], v[146:147], v[34:35]
    v_pk_fma_f32 v[20:21], v[52:53], v[148:149], v[20:21]
    v_pk_fma_f32 v[36:37], v[68:69], v[148:149], v[36:37]
    v_pk_fma_f32 v[22:23], v[54:55], v[150:151], v[22:23]
    v_pk_fma_f32 v[38:39], v[70:71], v[150:151], v[38:39]
    v_pk_mul_f32 v[50:51], v[106:107], s[74:75] op_sel_hi:[1,0]
    v_pk_mul_f32 v[66:67], v[104:105], s[74:75] op_sel_hi:[1,0]
    v_pk_mul_f32 v[52:53], v[102:103], s[78:79] op_sel_hi:[1,0]
    v_pk_mul_f32 v[68:69], v[100:101], s[78:79] op_sel_hi:[1,0]
    v_pk_mul_f32 v[54:55], v[98:99], s[76:77] op_sel_hi:[1,0]
    v_pk_mul_f32 v[70:71], v[96:97], s[76:77] op_sel_hi:[1,0]
    v_pk_fma_f32 v[50:51], v[104:105], s[76:77], v[50:51] op_sel_hi:[1,0,1]
    v_pk_fma_f32 v[66:67], v[106:107], s[76:77], v[66:67] op_sel_hi:[1,0,1] neg_lo:[1,0,0] neg_hi:[1,0,0]
    v_pk_fma_f32 v[52:53], v[100:101], s[78:79], v[52:53] op_sel_hi:[1,0,1]
    v_pk_fma_f32 v[68:69], v[102:103], s[78:79], v[68:69] op_sel_hi:[1,0,1] neg_lo:[1,0,0] neg_hi:[1,0,0]
    v_pk_fma_f32 v[54:55], v[96:97], s[74:75], v[54:55] op_sel_hi:[1,0,1]
    v_pk_fma_f32 v[70:71], v[98:99], s[74:75], v[70:71] op_sel_hi:[1,0,1] neg_lo:[1,0,0] neg_hi:[1,0,0]
    v_pk_mul_f32 v[24:25], v[24:25], v[136:137]
    v_pk_mul_f32 v[40:41], v[40:41], v[136:137]
    v_pk_mul_f32 v[26:27], v[26:27], v[138:139]
    v_pk_mul_f32 v[42:43], v[42:43], v[138:139]
    v_pk_mul_f32 v[28:29], v[28:29], v[140:141]
    v_pk_mul_f32 v[44:45], v[44:45], v[140:141]
    v_pk_mul_f32 v[30:31], v[30:31], v[142:143]
    v_pk_mul_f32 v[46:47], v[46:47], v[142:143]
    v_pk_fma_f32 v[96:97], v[72:73], v[152:153], v[40:41] neg_lo:[1,0,0] neg_hi:[1,0,0]
    v_pk_fma_f32 v[98:99], v[56:57], v[152:153], v[24:25] neg_lo:[0,0,1] neg_hi:[0,0,1]
    v_pk_fma_f32 v[100:101], v[58:59], v[154:155], v[26:27] neg_lo:[1,0,0] neg_hi:[1,0,0]
    v_pk_fma_f32 v[102:103], v[74:75], v[154:155], v[42:43] neg_lo:[1,0,0] neg_hi:[1,0,0]
    v_pk_fma_f32 v[104:105], v[60:61], v[156:157], v[28:29] neg_lo:[1,0,0] neg_hi:[1,0,0]
    v_pk_fma_f32 v[106:107], v[76:77], v[156:157], v[44:45] neg_lo:[1,0,0] neg_hi:[1,0,0]
    v_pk_fma_f32 v[64:65], v[62:63], v[158:159], v[30:31] neg_lo:[1,0,0] neg_hi:[1,0,0]
    v_pk_fma_f32 v[48:49], v[78:79], v[158:159], v[46:47] neg_lo:[1,0,0] neg_hi:[1,0,0]
    v_pk_fma_f32 v[24:25], v[56:57], v[152:153], v[24:25]
    v_pk_fma_f32 v[40:41], v[72:73], v[152:153], v[40:41]
    v_pk_fma_f32 v[26:27], v[58:59], v[154:155], v[26:27]
    v_pk_fma_f32 v[42:43], v[74:75], v[154:155], v[42:43]
    v_pk_fma_f32 v[28:29], v[60:61], v[156:157], v[28:29]
    v_pk_fma_f32 v[44:45], v[76:77], v[156:157], v[44:45]
    v_pk_fma_f32 v[30:31], v[62:63], v[158:159], v[30:31]
    v_pk_fma_f32 v[46:47], v[78:79], v[158:159], v[46:47]
    v_pk_mul_f32 v[58:59], v[100:101], s[76:77] op_sel_hi:[1,0] neg_lo:[0,1] neg_hi:[0,1]
    v_pk_mul_f32 v[74:75], v[102:103], s[76:77] op_sel_hi:[1,0] neg_lo:[0,1] neg_hi:[0,1]
    v_pk_mul_f32 v[60:61], v[104:105], s[78:79] op_sel_hi:[1,0] neg_lo:[0,1] neg_hi:[0,1]
    v_pk_mul_f32 v[76:77], v[106:107], s[78:79] op_sel_hi:[1,0] neg_lo:[0,1] neg_hi:[0,1]
    v_pk_mul_f32 v[62:63], v[64:65], s[74:75] op_sel_hi:[1,0] neg_lo:[0,1] neg_hi:[0,1]
    v_pk_mul_f32 v[78:79], v[48:49], s[74:75] op_sel_hi:[1,0] neg_lo:[0,1] neg_hi:[0,1]
    v_pk_fma_f32 v[58:59], v[102:103], s[74:75], v[58:59] op_sel_hi:[1,0,1]
    v_pk_fma_f32 v[74:75], v[100:101], s[74:75], v[74:75] op_sel_hi:[1,0,1] neg_lo:[1,0,0] neg_hi:[1,0,0]
    v_pk_fma_f32 v[60:61], v[106:107], s[78:79], v[60:61] op_sel_hi:[1,0,1]
    v_pk_fma_f32 v[76:77], v[104:105], s[78:79], v[76:77] op_sel_hi:[1,0,1] neg_lo:[1,0,0] neg_hi:[1,0,0]
    v_pk_fma_f32 v[62:63], v[48:49], s[76:77], v[62:63] op_sel_hi:[1,0,1]
    v_pk_fma_f32 v[78:79], v[64:65], s[76:77], v[78:79] op_sel_hi:[1,0,1] neg_lo:[1,0,0] neg_hi:[1,0,0]
    v_pk_add_f32 v[48:49], v[16:17], v[24:25] neg_lo:[0,1] neg_hi:[0,1]
    v_pk_add_f32 v[64:65], v[32:33], v[40:41] neg_lo:[0,1] neg_hi:[0,1]
    v_pk_add_f32 v[106:107], v[18:19], v[26:27] neg_lo:[0,1] neg_hi:[0,1]
    v_pk_add_f32 v[104:105], v[34:35], v[42:43] neg_lo:[0,1] neg_hi:[0,1]
    v_pk_add_f32 v[102:103], v[36:37], v[44:45] neg_lo:[0,1] neg_hi:[0,1]
    v_pk_add_f32 v[100:101], v[28:29], v[20:21] neg_lo:[0,1] neg_hi:[0,1]
    v_pk_add_f32 v[72:73], v[22:23], v[30:31] neg_lo:[0,1] neg_hi:[0,1]
    v_pk_add_f32 v[56:57], v[38:39], v[46:47] neg_lo:[0,1] neg_hi:[0,1]
    v_pk_add_f32 v[16:17], v[16:17], v[24:25]
    v_pk_add_f32 v[32:33], v[32:33], v[40:41]
    v_pk_add_f32 v[18:19], v[18:19], v[26:27]
    v_pk_add_f32 v[34:35], v[34:35], v[42:43]
    v_pk_add_f32 v[20:21], v[20:21], v[28:29]
    v_pk_add_f32 v[36:37], v[36:37], v[44:45]
    v_pk_add_f32 v[22:23], v[22:23], v[30:31]
    v_pk_add_f32 v[38:39], v[38:39], v[46:47]
    v_pk_mul_f32 v[26:27], v[106:107], s[78:79] op_sel_hi:[1,0]
    v_pk_mul_f32 v[42:43], v[104:105], s[78:79] op_sel_hi:[1,0]
    v_pk_mul_f32 v[30:31], v[72:73], s[78:79] op_sel_hi:[1,0] neg_lo:[0,1] neg_hi:[0,1]
    v_pk_mul_f32 v[46:47], v[56:57], s[78:79] op_sel_hi:[1,0] neg_lo:[0,1] neg_hi:[0,1]
    v_pk_fma_f32 v[26:27], v[104:105], s[78:79], v[26:27] op_sel_hi:[1,0,1]
    v_pk_fma_f32 v[42:43], v[106:107], s[78:79], v[42:43] op_sel_hi:[1,0,1] neg_lo:[1,0,0] neg_hi:[1,0,0]
    v_pk_fma_f32 v[30:31], v[56:57], s[78:79], v[30:31] op_sel_hi:[1,0,1]
    v_pk_fma_f32 v[46:47], v[72:73], s[78:79], v[46:47] op_sel_hi:[1,0,1] neg_lo:[1,0,0] neg_hi:[1,0,0]
    v_pk_add_f32 v[56:57], v[16:17], v[20:21] neg_lo:[0,1] neg_hi:[0,1]
    v_pk_add_f32 v[72:73], v[32:33], v[36:37] neg_lo:[0,1] neg_hi:[0,1]
    v_pk_add_f32 v[104:105], v[34:35], v[38:39] neg_lo:[0,1] neg_hi:[0,1]
    v_pk_add_f32 v[106:107], v[22:23], v[18:19] neg_lo:[0,1] neg_hi:[0,1]
    v_pk_add_f32 v[44:45], v[48:49], v[102:103] neg_lo:[0,1] neg_hi:[0,1]
    v_pk_add_f32 v[28:29], v[64:65], v[100:101] neg_lo:[0,1] neg_hi:[0,1]
    v_pk_add_f32 v[40:41], v[42:43], v[46:47] neg_lo:[0,1] neg_hi:[0,1]
    v_pk_add_f32 v[24:25], v[30:31], v[26:27] neg_lo:[0,1] neg_hi:[0,1]
    v_pk_add_f32 v[16:17], v[16:17], v[20:21]
    v_pk_add_f32 v[32:33], v[32:33], v[36:37]
    v_pk_add_f32 v[18:19], v[18:19], v[22:23]
    v_pk_add_f32 v[34:35], v[34:35], v[38:39]
    v_pk_add_f32 v[48:49], v[48:49], v[102:103]
    v_pk_add_f32 v[64:65], v[64:65], v[100:101]
    v_pk_add_f32 v[26:27], v[26:27], v[30:31]
    v_pk_add_f32 v[42:43], v[42:43], v[46:47]
    v_pk_add_f32 v[46:47], v[16:17], v[18:19] neg_lo:[0,1] neg_hi:[0,1]
    v_pk_add_f32 v[30:31], v[32:33], v[34:35] neg_lo:[0,1] neg_hi:[0,1]
    v_pk_add_f32 v[100:101], v[56:57], v[104:105] neg_lo:[0,1] neg_hi:[0,1]
    v_pk_add_f32 v[102:103], v[72:73], v[106:107] neg_lo:[0,1] neg_hi:[0,1]
    v_pk_add_f32 v[16:17], v[16:17], v[18:19]
    v_pk_add_f32 v[32:33], v[32:33], v[34:35]
    v_pk_add_f32 v[56:57], v[56:57], v[104:105]
    v_pk_add_f32 v[72:73], v[72:73], v[106:107]
    v_cvt_pk_bf16_f32 v128, v16, v17
    v_cvt_pk_bf16_f32 v130, v32, v33
    v_cvt_pk_bf16_f32 v129, v46, v47
    v_cvt_pk_bf16_f32 v131, v30, v31
    v_cvt_pk_bf16_f32 v132, v56, v57
    v_cvt_pk_bf16_f32 v134, v72, v73
    v_cvt_pk_bf16_f32 v133, v100, v101
    v_cvt_pk_bf16_f32 v135, v102, v103
    s_add_u32 s71, s54, 0
    s_add_u32 s72, s54, 524288
    v_permlane32_swap_b32 v128, v129
    v_permlane32_swap_b32 v130, v131
    v_permlane32_swap_b32 v132, v133
    v_permlane32_swap_b32 v134, v135
    buffer_store_dwordx4 v[128:131], v4, s[20:23], s71 offen sc1
    buffer_store_dwordx4 v[132:135], v4, s[20:23], s72 offen sc1
    v_pk_add_f32 v[106:107], v[48:49], v[26:27] neg_lo:[0,1] neg_hi:[0,1]
    v_pk_add_f32 v[104:105], v[64:65], v[42:43] neg_lo:[0,1] neg_hi:[0,1]
    v_pk_add_f32 v[34:35], v[44:45], v[40:41] neg_lo:[0,1] neg_hi:[0,1]
    v_pk_add_f32 v[18:19], v[28:29], v[24:25] neg_lo:[0,1] neg_hi:[0,1]
    v_pk_add_f32 v[48:49], v[48:49], v[26:27]
    v_pk_add_f32 v[64:65], v[64:65], v[42:43]
    v_pk_add_f32 v[44:45], v[44:45], v[40:41]
    v_pk_add_f32 v[28:29], v[28:29], v[24:25]
    v_cvt_pk_bf16_f32 v136, v48, v49
    v_cvt_pk_bf16_f32 v138, v64, v65
    v_cvt_pk_bf16_f32 v137, v106, v107
    v_cvt_pk_bf16_f32 v139, v104, v105
    v_cvt_pk_bf16_f32 v140, v44, v45
    v_cvt_pk_bf16_f32 v142, v28, v29
    v_cvt_pk_bf16_f32 v141, v34, v35
    v_cvt_pk_bf16_f32 v143, v18, v19
    s_add_u32 s71, s54, 262144
    s_add_u32 s72, s54, 786432
    v_permlane32_swap_b32 v136, v137
    v_permlane32_swap_b32 v138, v139
    v_permlane32_swap_b32 v140, v141
    v_permlane32_swap_b32 v142, v143
    buffer_store_dwordx4 v[136:139], v4, s[20:23], s71 offen sc1
    buffer_store_dwordx4 v[140:143], v4, s[20:23], s72 offen sc1
    v_pk_add_f32 v[24:25], v[110:111], v[96:97] neg_lo:[0,1] neg_hi:[0,1]
    v_pk_add_f32 v[40:41], v[108:109], v[98:99] neg_lo:[0,1] neg_hi:[0,1]
    v_pk_add_f32 v[42:43], v[50:51], v[58:59] neg_lo:[0,1] neg_hi:[0,1]
    v_pk_add_f32 v[26:27], v[66:67], v[74:75] neg_lo:[0,1] neg_hi:[0,1]
    v_pk_add_f32 v[38:39], v[68:69], v[76:77] neg_lo:[0,1] neg_hi:[0,1]
    v_pk_add_f32 v[22:23], v[60:61], v[52:53] neg_lo:[0,1] neg_hi:[0,1]
    v_pk_add_f32 v[36:37], v[54:55], v[62:63] neg_lo:[0,1] neg_hi:[0,1]
    v_pk_add_f32 v[20:21], v[70:71], v[78:79] neg_lo:[0,1] neg_hi:[0,1]
    v_pk_add_f32 v[110:111], v[110:111], v[96:97]
    v_pk_add_f32 v[108:109], v[108:109], v[98:99]
    v_pk_add_f32 v[50:51], v[50:51], v[58:59]
    v_pk_add_f32 v[66:67], v[66:67], v[74:75]
    v_pk_add_f32 v[52:53], v[52:53], v[60:61]
    v_pk_add_f32 v[68:69], v[68:69], v[76:77]
    v_pk_add_f32 v[54:55], v[54:55], v[62:63]
    v_pk_add_f32 v[70:71], v[70:71], v[78:79]
    v_pk_mul_f32 v[58:59], v[42:43], s[78:79] op_sel_hi:[1,0]
    v_pk_mul_f32 v[74:75], v[26:27], s[78:79] op_sel_hi:[1,0]
    v_pk_mul_f32 v[62:63], v[36:37], s[78:79] op_sel_hi:[1,0] neg_lo:[0,1] neg_hi:[0,1]
    v_pk_mul_f32 v[78:79], v[20:21], s[78:79] op_sel_hi:[1,0] neg_lo:[0,1] neg_hi:[0,1]
    v_pk_fma_f32 v[58:59], v[26:27], s[78:79], v[58:59] op_sel_hi:[1,0,1]
    v_pk_fma_f32 v[74:75], v[42:43], s[78:79], v[74:75] op_sel_hi:[1,0,1] neg_lo:[1,0,0] neg_hi:[1,0,0]
    v_pk_fma_f32 v[62:63], v[20:21], s[78:79], v[62:63] op_sel_hi:[1,0,1]
    v_pk_fma_f32 v[78:79], v[36:37], s[78:79], v[78:79] op_sel_hi:[1,0,1] neg_lo:[1,0,0] neg_hi:[1,0,0]
    v_pk_add_f32 v[20:21], v[110:111], v[52:53] neg_lo:[0,1] neg_hi:[0,1]
    v_pk_add_f32 v[36:37], v[108:109], v[68:69] neg_lo:[0,1] neg_hi:[0,1]
    v_pk_add_f32 v[26:27], v[66:67], v[70:71] neg_lo:[0,1] neg_hi:[0,1]
    v_pk_add_f32 v[42:43], v[54:55], v[50:51] neg_lo:[0,1] neg_hi:[0,1]
    v_pk_add_f32 v[76:77], v[24:25], v[38:39] neg_lo:[0,1] neg_hi:[0,1]
    v_pk_add_f32 v[60:61], v[40:41], v[22:23] neg_lo:[0,1] neg_hi:[0,1]
    v_pk_add_f32 v[98:99], v[74:75], v[78:79] neg_lo:[0,1] neg_hi:[0,1]
    v_pk_add_f32 v[96:97], v[62:63], v[58:59] neg_lo:[0,1] neg_hi:[0,1]
    v_pk_add_f32 v[110:111], v[110:111], v[52:53]
    v_pk_add_f32 v[108:109], v[108:109], v[68:69]
    v_pk_add_f32 v[50:51], v[50:51], v[54:55]
    v_pk_add_f32 v[66:67], v[66:67], v[70:71]
    v_pk_add_f32 v[24:25], v[24:25], v[38:39]
    v_pk_add_f32 v[40:41], v[40:41], v[22:23]
    v_pk_add_f32 v[58:59], v[58:59], v[62:63]
    v_pk_add_f32 v[74:75], v[74:75], v[78:79]
    v_pk_add_f32 v[78:79], v[110:111], v[50:51] neg_lo:[0,1] neg_hi:[0,1]
    v_pk_add_f32 v[62:63], v[108:109], v[66:67] neg_lo:[0,1] neg_hi:[0,1]
    v_pk_add_f32 v[22:23], v[20:21], v[26:27] neg_lo:[0,1] neg_hi:[0,1]
    v_pk_add_f32 v[38:39], v[36:37], v[42:43] neg_lo:[0,1] neg_hi:[0,1]
    v_pk_add_f32 v[110:111], v[110:111], v[50:51]
    v_pk_add_f32 v[108:109], v[108:109], v[66:67]
    v_pk_add_f32 v[20:21], v[20:21], v[26:27]
    v_pk_add_f32 v[36:37], v[36:37], v[42:43]
    v_cvt_pk_bf16_f32 v144, v110, v111
    v_cvt_pk_bf16_f32 v146, v108, v109
    v_cvt_pk_bf16_f32 v145, v78, v79
    v_cvt_pk_bf16_f32 v147, v62, v63
    v_cvt_pk_bf16_f32 v148, v20, v21
    v_cvt_pk_bf16_f32 v150, v36, v37
    v_cvt_pk_bf16_f32 v149, v22, v23
    v_cvt_pk_bf16_f32 v151, v38, v39
    s_add_u32 s71, s54, 131072
    s_add_u32 s72, s54, 655360
    v_permlane32_swap_b32 v144, v145
    v_permlane32_swap_b32 v146, v147
    v_permlane32_swap_b32 v148, v149
    v_permlane32_swap_b32 v150, v151
    buffer_store_dwordx4 v[144:147], v4, s[20:23], s71 offen sc1
    buffer_store_dwordx4 v[148:151], v4, s[20:23], s72 offen sc1
    v_pk_add_f32 v[42:43], v[24:25], v[58:59] neg_lo:[0,1] neg_hi:[0,1]
    v_pk_add_f32 v[26:27], v[40:41], v[74:75] neg_lo:[0,1] neg_hi:[0,1]
    v_pk_add_f32 v[66:67], v[76:77], v[98:99] neg_lo:[0,1] neg_hi:[0,1]
    v_pk_add_f32 v[50:51], v[60:61], v[96:97] neg_lo:[0,1] neg_hi:[0,1]
    v_pk_add_f32 v[24:25], v[24:25], v[58:59]
    v_pk_add_f32 v[40:41], v[40:41], v[74:75]
    v_pk_add_f32 v[76:77], v[76:77], v[98:99]
    v_pk_add_f32 v[60:61], v[60:61], v[96:97]
    v_cvt_pk_bf16_f32 v152, v24, v25
    v_cvt_pk_bf16_f32 v154, v40, v41
    v_cvt_pk_bf16_f32 v153, v42, v43
    v_cvt_pk_bf16_f32 v155, v26, v27
    v_cvt_pk_bf16_f32 v156, v76, v77
    v_cvt_pk_bf16_f32 v158, v60, v61
    v_cvt_pk_bf16_f32 v157, v66, v67
    v_cvt_pk_bf16_f32 v159, v50, v51
    s_add_u32 s71, s54, 393216
    s_add_u32 s72, s54, 917504
    v_permlane32_swap_b32 v152, v153
    v_permlane32_swap_b32 v154, v155
    v_permlane32_swap_b32 v156, v157
    v_permlane32_swap_b32 v158, v159
    buffer_store_dwordx4 v[152:155], v4, s[20:23], s71 offen sc1
    buffer_store_dwordx4 v[156:159], v4, s[20:23], s72 offen sc1
L_p2:
    s_mov_b32 s8, s26
    s_mov_b32 s9, s27
    s_mov_b32 s10, 2097152
    s_mov_b32 s11, 0x20000
    s_and_b32 s65, s68, 1
    s_lshl_b32 s72, s65, 9
    s_add_u32 s72, s72, s70
    s_lshl_b32 s72, s72, 10
    s_lshl_b32 s64, s69, 7
    s_add_u32 s72, s72, s64
    v_bfe_u32 v2, v0, 3, 5
    v_lshrrev_b32 v3, 8, v0
    v_lshlrev_b32 v7, 14, v2
    v_lshl_add_u32 v7, v3, 20, v7
    v_and_b32 v3, 7, v0
    v_lshl_add_u32 v7, v3, 4, v7
    v_add_u32 v5, 229376, v6
    s_lshl_b32 s64, s70, 2
    s_add_u32 s64, s64, s65
    s_mul_i32 s64, s64, 114688
    s_lshl_b32 s65, s50, 15
    s_add_u32 s64, s64, s65
    s_cmp_ge_u32 s50, 4
    s_cselect_b32 s65, 110592, 0
    s_sub_u32 s74, s64, s65
    s_cmp_ge_u32 s50, 4
    s_cselect_b32 s65, 110592, 0
    s_sub_u32 s75, s64, s65
    s_add_u32 s75, s75, 8192
    s_cmp_ge_u32 s50, 3
    s_cselect_b32 s65, 110592, 0
    s_sub_u32 s76, s64, s65
    s_add_u32 s76, s76, 16384
    s_cmp_ge_u32 s50, 3
    s_cselect_b32 s65, 110592, 0
    s_sub_u32 s77, s64, s65
    s_add_u32 s77, s77, 24576
    s_cmp_eq_u32 s50, 7
    s_cbranch_scc1 L_p2_dft
    s_waitcnt vmcnt(0)
    v_mov_b32 v2, 147460
    v_mov_b32 v3, 1
    s_mov_b64 exec, 1
    ds_add_rtn_u32 v3, v2, v3
    s_waitcnt lgkmcnt(0)
    v_readfirstlane_b32 s73, v3
    s_mov_b64 exec, -1
    s_cmp_lg_u32 s73, s3
    s_cbranch_scc1 L_ar91
    s_cmp_eq_u32 s67, 1
    s_cbranch_scc1 L_az92
    s_atomic_swap_x2 s[34:35], s[30:31], s55
L_ar91:
    s_setprio 0
L_rest:
    buffer_load_dwordx4 v[80:83], v6, s[20:23], s51 offen offset:0 sc1
    buffer_load_dwordx4 v[84:87], v6, s[20:23], s51 offen offset:1024 sc1
    buffer_load_dwordx4 v[88:91], v6, s[20:23], s51 offen offset:2048 sc1
    buffer_load_dwordx4 v[92:95], v6, s[20:23], s51 offen offset:3072 sc1
    s_add_u32 s51, s51, 4096
    buffer_load_dwordx4 v[96:99], v6, s[20:23], s51 offen offset:0 sc1
    buffer_load_dwordx4 v[100:103], v6, s[20:23], s51 offen offset:1024 sc1
    buffer_load_dwordx4 v[104:107], v6, s[20:23], s51 offen offset:2048 sc1
    buffer_load_dwordx4 v[108:111], v6, s[20:23], s51 offen offset:3072 sc1
    s_add_u32 s51, s51, 4096
    buffer_load_dwordx4 v[112:115], v6, s[20:23], s51 offen offset:0 sc1
    buffer_load_dwordx4 v[116:119], v6, s[20:23], s51 offen offset:1024 sc1
    buffer_load_dwordx4 v[120:123], v6, s[20:23], s51 offen offset:2048 sc1
    buffer_load_dwordx4 v[124:127], v6, s[20:23], s51 offen offset:3072 sc1
    s_add_u32 s51, s51, 4096
    buffer_load_dwordx4 v[128:131], v6, s[20:23], s51 offen offset:0 sc1
    buffer_load_dwordx4 v[132:135], v6, s[20:23], s51 offen offset:1024 sc1
    buffer_load_dwordx4 v[136:139], v6, s[20:23], s51 offen offset:2048 sc1
    buffer_load_dwordx4 v[140:143], v6, s[20:23], s51 offen offset:3072 sc1
    s_add_u32 s51, s51, 4096
L_go:
    s_cmp_eq_u32 s50, 3
    s_cbranch_scc1 L_go3
    s_mov_b32 s73, 0
L_pl93:
    s_load_dwordx2 s[12:13], s[36:37], 0 glc
    s_load_dwordx2 s[14:15], s[36:37], 128 glc
    s_load_dwordx2 s[16:17], s[36:37], 256 glc
    s_load_dwordx2 s[18:19], s[36:37], 384 glc
    s_add_u32 s73, s73, 1
    s_cmp_ge_u32 s73, 65536
    s_waitcnt lgkmcnt(0)
    s_cbranch_scc1 L_pl94
    s_xor_b64 s[12:13], s[12:13], s[34:35]
    s_xor_b64 s[14:15], s[14:15], s[34:35]
    s_xor_b64 s[16:17], s[16:17], s[34:35]
    s_xor_b64 s[18:19], s[18:19], s[34:35]
    s_or_b64 s[12:13], s[12:13], s[14:15]
    s_or_b64 s[12:13], s[12:13], s[16:17]
    s_or_b64 s[12:13], s[12:13], s[18:19]
    s_cbranch_scc0 L_pl94
    s_sleep 1
    s_branch L_pl93
L_pl94:
    buffer_load_dwordx4 v[144:147], v6, s[20:23], s74 offen offset:0 sc1
    buffer_load_dwordx4 v[148:151], v5, s[20:23], s74 offen offset:0 sc1
    buffer_load_dwordx4 v[152:155], v6, s[20:23], s74 offen offset:1024 sc1
    buffer_load_dwordx4 v[156:159], v5, s[20:23], s74 offen offset:1024 sc1
    buffer_load_dwordx4 v[160:163], v6, s[20:23], s74 offen offset:2048 sc1
    buffer_load_dwordx4 v[164:167], v5, s[20:23], s74 offen offset:2048 sc1
    buffer_load_dwordx4 v[168:171], v6, s[20:23], s74 offen offset:3072 sc1
    buffer_load_dwordx4 v[172:175], v5, s[20:23], s74 offen offset:3072 sc1
    buffer_load_dwordx4 v[176:179], v6, s[20:23], s75 offen offset:0 sc1
    buffer_load_dwordx4 v[180:183], v5, s[20:23], s75 offen offset:0 sc1
    buffer_load_dwordx4 v[184:187], v6, s[20:23], s75 offen offset:1024 sc1
    buffer_load_dwordx4 v[188:191], v5, s[20:23], s75 offen offset:1024 sc1
    s_waitcnt vmcnt(10)
    v_mfma_f32_32x32x16_bf16 v[16:31], v[192:195], v[144:147], 0
    v_mfma_f32_32x32x16_bf16 v[32:47], v[196:199], v[144:147], 0
    v_mfma_f32_32x32x16_bf16 v[48:63], v[192:195], v[148:151], 0
    v_mfma_f32_32x32x16_bf16 v[64:79], v[196:199], v[148:151], 0
    buffer_load_dwordx4 v[144:147], v6, s[20:23], s75 offen offset:2048 sc1
    buffer_load_dwordx4 v[148:151], v5, s[20:23], s75 offen offset:2048 sc1
    buffer_load_dwordx4 v[192:195], v6, s[20:23], s75 offen offset:3072 sc1
    buffer_load_dwordx4 v[196:199], v5, s[20:23], s75 offen offset:3072 sc1
    s_waitcnt vmcnt(12)
    v_mfma_f32_32x32x16_bf16 v[16:31], v[200:203], v[152:155], v[16:31]
    v_mfma_f32_32x32x16_bf16 v[32:47], v[204:207], v[152:155], v[32:47]
    v_mfma_f32_32x32x16_bf16 v[48:63], v[200:203], v[156:159], v[48:63]
    v_mfma_f32_32x32x16_bf16 v[64:79], v[204:207], v[156:159], v[64:79]
    buffer_load_dwordx4 v[152:155], v6, s[20:23], s76 offen offset:0 sc1
    buffer_load_dwordx4 v[156:159], v5, s[20:23], s76 offen offset:0 sc1
    buffer_load_dwordx4 v[200:203], v6, s[20:23], s76 offen offset:1024 sc1
    buffer_load_dwordx4 v[204:207], v5, s[20:23], s76 offen offset:1024 sc1
    s_waitcnt vmcnt(14)
    v_mfma_f32_32x32x16_bf16 v[16:31], v[208:211], v[160:163], v[16:31]
    v_mfma_f32_32x32x16_bf16 v[32:47], v[212:215], v[160:163], v[32:47]
    v_mfma_f32_32x32x16_bf16 v[48:63], v[208:211], v[164:167], v[48:63]
    v_mfma_f32_32x32x16_bf16 v[64:79], v[212:215], v[164:167], v[64:79]
    buffer_load_dwordx4 v[160:163], v6, s[20:23], s76 offen offset:2048 sc1
    buffer_load_dwordx4 v[164:167], v5, s[20:23], s76 offen offset:2048 sc1
    buffer_load_dwordx4 v[208:211], v6, s[20:23], s76 offen offset:3072 sc1
    buffer_load_dwordx4 v[212:215], v5, s[20:23], s76 offen offset:3072 sc1
    s_waitcnt vmcnt(16)
    v_mfma_f32_32x32x16_bf16 v[16:31], v[216:219], v[168:171], v[16:31]
    v_mfma_f32_32x32x16_bf16 v[32:47], v[220:223], v[168:171], v[32:47]
    v_mfma_f32_32x32x16_bf16 v[48:63], v[216:219], v[172:175], v[48:63]
    v_mfma_f32_32x32x16_bf16 v[64:79], v[220:223], v[172:175], v[64:79]
    buffer_load_dwordx4 v[168:171], v6, s[20:23], s77 offen offset:0 sc1
    buffer_load_dwordx4 v[172:175], v5, s[20:23], s77 offen offset:0 sc1
    buffer_load_dwordx4 v[216:219], v6, s[20:23], s77 offen offset:1024 sc1
    buffer_load_dwordx4 v[220:223], v5, s[20:23], s77 offen offset:1024 sc1
    s_waitcnt vmcnt(18)
    v_mfma_f32_32x32x16_bf16 v[16:31], v[224:227], v[176:179], v[16:31]
    v_mfma_f32_32x32x16_bf16 v[32:47], v[228:231], v[176:179], v[32:47]
    v_mfma_f32_32x32x16_bf16 v[48:63], v[224:227], v[180:183], v[48:63]
    v_mfma_f32_32x32x16_bf16 v[64:79], v[228:231], v[180:183], v[64:79]
    buffer_load_dwordx4 v[176:179], v6, s[20:23], s77 offen offset:2048 sc1
    buffer_load_dwordx4 v[180:183], v5, s[20:23], s77 offen offset:2048 sc1
    buffer_load_dwordx4 v[224:227], v6, s[20:23], s77 offen offset:3072 sc1
    buffer_load_dwordx4 v[228:231], v5, s[20:23], s77 offen offset:3072 sc1
    buffer_load_dwordx4 v[12:15], v7, s[4:7], s72 offen
    s_waitcnt vmcnt(21)
    v_mfma_f32_32x32x16_bf16 v[16:31], v[232:235], v[184:187], v[16:31]
    v_mfma_f32_32x32x16_bf16 v[32:47], v[236:239], v[184:187], v[32:47]
    v_mfma_f32_32x32x16_bf16 v[48:63], v[232:235], v[188:191], v[48:63]
    v_mfma_f32_32x32x16_bf16 v[64:79], v[236:239], v[188:191], v[64:79]
    s_waitcnt vmcnt(19)
    v_mfma_f32_32x32x16_bf16 v[16:31], v[240:243], v[144:147], v[16:31]
    v_mfma_f32_32x32x16_bf16 v[32:47], v[244:247], v[144:147], v[32:47]
    v_mfma_f32_32x32x16_bf16 v[48:63], v[240:243], v[148:151], v[48:63]
    v_mfma_f32_32x32x16_bf16 v[64:79], v[244:247], v[148:151], v[64:79]
    s_waitcnt vmcnt(17)
    v_mfma_f32_32x32x16_bf16 v[16:31], v[248:251], v[192:195], v[16:31]
    v_mfma_f32_32x32x16_bf16 v[32:47], v[252:255], v[192:195], v[32:47]
    v_mfma_f32_32x32x16_bf16 v[48:63], v[248:251], v[196:199], v[48:63]
    v_mfma_f32_32x32x16_bf16 v[64:79], v[252:255], v[196:199], v[64:79]
    s_waitcnt vmcnt(15)
    v_mfma_f32_32x32x16_bf16 v[16:31], v[80:83], v[152:155], v[16:31]
    v_mfma_f32_32x32x16_bf16 v[32:47], v[84:87], v[152:155], v[32:47]
    v_mfma_f32_32x32x16_bf16 v[48:63], v[80:83], v[156:159], v[48:63]
    v_mfma_f32_32x32x16_bf16 v[64:79], v[84:87], v[156:159], v[64:79]
    s_waitcnt vmcnt(13)
    v_mfma_f32_32x32x16_bf16 v[16:31], v[88:91], v[200:203], v[16:31]
    v_mfma_f32_32x32x16_bf16 v[32:47], v[92:95], v[200:203], v[32:47]
    v_mfma_f32_32x32x16_bf16 v[48:63], v[88:91], v[204:207], v[48:63]
    v_mfma_f32_32x32x16_bf16 v[64:79], v[92:95], v[204:207], v[64:79]
    s_waitcnt vmcnt(11)
    v_mfma_f32_32x32x16_bf16 v[16:31], v[96:99], v[160:163], v[16:31]
    v_mfma_f32_32x32x16_bf16 v[32:47], v[100:103], v[160:163], v[32:47]
    v_mfma_f32_32x32x16_bf16 v[48:63], v[96:99], v[164:167], v[48:63]
    v_mfma_f32_32x32x16_bf16 v[64:79], v[100:103], v[164:167], v[64:79]
    s_waitcnt vmcnt(9)
    v_mfma_f32_32x32x16_bf16 v[16:31], v[104:107], v[208:211], v[16:31]
    v_mfma_f32_32x32x16_bf16 v[32:47], v[108:111], v[208:211], v[32:47]
    v_mfma_f32_32x32x16_bf16 v[48:63], v[104:107], v[212:215], v[48:63]
    v_mfma_f32_32x32x16_bf16 v[64:79], v[108:111], v[212:215], v[64:79]
    s_waitcnt vmcnt(7)
    v_mfma_f32_32x32x16_bf16 v[16:31], v[112:115], v[168:171], v[16:31]
    v_mfma_f32_32x32x16_bf16 v[32:47], v[116:119], v[168:171], v[32:47]
    v_mfma_f32_32x32x16_bf16 v[48:63], v[112:115], v[172:175], v[48:63]
    v_mfma_f32_32x32x16_bf16 v[64:79], v[116:119], v[172:175], v[64:79]
    s_waitcnt vmcnt(5)
    v_mfma_f32_32x32x16_bf16 v[16:31], v[120:123], v[216:219], v[16:31]
    v_mfma_f32_32x32x16_bf16 v[32:47], v[124:127], v[216:219], v[32:47]
    v_mfma_f32_32x32x16_bf16 v[48:63], v[120:123], v[220:223], v[48:63]
    v_mfma_f32_32x32x16_bf16 v[64:79], v[124:127], v[220:223], v[64:79]
    s_waitcnt vmcnt(3)
    v_mfma_f32_32x32x16_bf16 v[16:31], v[128:131], v[176:179], v[16:31]
    v_mfma_f32_32x32x16_bf16 v[32:47], v[132:135], v[176:179], v[32:47]
    v_mfma_f32_32x32x16_bf16 v[48:63], v[128:131], v[180:183], v[48:63]
    v_mfma_f32_32x32x16_bf16 v[64:79], v[132:135], v[180:183], v[64:79]
    s_waitcnt vmcnt(1)
    v_mfma_f32_32x32x16_bf16 v[16:31], v[136:139], v[224:227], v[16:31]
    v_mfma_f32_32x32x16_bf16 v[32:47], v[140:143], v[224:227], v[32:47]
    v_mfma_f32_32x32x16_bf16 v[48:63], v[136:139], v[228:231], v[48:63]
    v_mfma_f32_32x32x16_bf16 v[64:79], v[140:143], v[228:231], v[64:79]
    s_branch L_red
L_go3:
    s_mov_b32 s73, 0
L_pl95:
    s_load_dwordx2 s[12:13], s[36:37], 0 glc
    s_load_dwordx2 s[14:15], s[36:37], 128 glc
    s_add_u32 s73, s73, 1
    s_cmp_ge_u32 s73, 65536
    s_waitcnt lgkmcnt(0)
    s_cbranch_scc1 L_pl96
    s_xor_b64 s[12:13], s[12:13], s[34:35]
    s_xor_b64 s[14:15], s[14:15], s[34:35]
    s_or_b64 s[12:13], s[12:13], s[14:15]
    s_cbranch_scc0 L_pl96
    s_sleep 1
    s_branch L_pl95
L_pl96:
    buffer_load_dwordx4 v[144:147], v6, s[20:23], s74 offen offset:0 sc1
    buffer_load_dwordx4 v[148:151], v5, s[20:23], s74 offen offset:0 sc1
    buffer_load_dwordx4 v[152:155], v6, s[20:23], s74 offen offset:1024 sc1
    buffer_load_dwordx4 v[156:159], v5, s[20:23], s74 offen offset:1024 sc1
    buffer_load_dwordx4 v[160:163], v6, s[20:23], s74 offen offset:2048 sc1
    buffer_load_dwordx4 v[164:167], v5, s[20:23], s74 offen offset:2048 sc1
    buffer_load_dwordx4 v[168:171], v6, s[20:23], s74 offen offset:3072 sc1
    buffer_load_dwordx4 v[172:175], v5, s[20:23], s74 offen offset:3072 sc1
    buffer_load_dwordx4 v[176:179], v6, s[20:23], s75 offen offset:0 sc1
    buffer_load_dwordx4 v[180:183], v5, s[20:23], s75 offen offset:0 sc1
    buffer_load_dwordx4 v[184:187], v6, s[20:23], s75 offen offset:1024 sc1
    buffer_load_dwordx4 v[188:191], v5, s[20:23], s75 offen offset:1024 sc1
    s_waitcnt vmcnt(10)
    v_mfma_f32_32x32x16_bf16 v[16:31], v[192:195], v[144:147], 0
    v_mfma_f32_32x32x16_bf16 v[32:47], v[196:199], v[144:147], 0
    v_mfma_f32_32x32x16_bf16 v[48:63], v[192:195], v[148:151], 0
    v_mfma_f32_32x32x16_bf16 v[64:79], v[196:199], v[148:151], 0
    buffer_load_dwordx4 v[144:147], v6, s[20:23], s75 offen offset:2048 sc1
    buffer_load_dwordx4 v[148:151], v5, s[20:23], s75 offen offset:2048 sc1
    buffer_load_dwordx4 v[192:195], v6, s[20:23], s75 offen offset:3072 sc1
    buffer_load_dwordx4 v[196:199], v5, s[20:23], s75 offen offset:3072 sc1
    s_waitcnt vmcnt(12)
    v_mfma_f32_32x32x16_bf16 v[16:31], v[200:203], v[152:155], v[16:31]
    v_mfma_f32_32x32x16_bf16 v[32:47], v[204:207], v[152:155], v[32:47]
    v_mfma_f32_32x32x16_bf16 v[48:63], v[200:203], v[156:159], v[48:63]
    v_mfma_f32_32x32x16_bf16 v[64:79], v[204:207], v[156:159], v[64:79]
    s_waitcnt vmcnt(10)
    v_mfma_f32_32x32x16_bf16 v[16:31], v[208:211], v[160:163], v[16:31]
    v_mfma_f32_32x32x16_bf16 v[32:47], v[212:215], v[160:163], v[32:47]
    v_mfma_f32_32x32x16_bf16 v[48:63], v[208:211], v[164:167], v[48:63]
    v_mfma_f32_32x32x16_bf16 v[64:79], v[212:215], v[164:167], v[64:79]
    s_waitcnt vmcnt(8)
    v_mfma_f32_32x32x16_bf16 v[16:31], v[216:219], v[168:171], v[16:31]
    v_mfma_f32_32x32x16_bf16 v[32:47], v[220:223], v[168:171], v[32:47]
    v_mfma_f32_32x32x16_bf16 v[48:63], v[216:219], v[172:175], v[48:63]
    v_mfma_f32_32x32x16_bf16 v[64:79], v[220:223], v[172:175], v[64:79]
    s_waitcnt vmcnt(6)
    v_mfma_f32_32x32x16_bf16 v[16:31], v[224:227], v[176:179], v[16:31]
    v_mfma_f32_32x32x16_bf16 v[32:47], v[228:231], v[176:179], v[32:47]
    v_mfma_f32_32x32x16_bf16 v[48:63], v[224:227], v[180:183], v[48:63]
    v_mfma_f32_32x32x16_bf16 v[64:79], v[228:231], v[180:183], v[64:79]
    s_waitcnt vmcnt(4)
    v_mfma_f32_32x32x16_bf16 v[16:31], v[232:235], v[184:187], v[16:31]
    v_mfma_f32_32x32x16_bf16 v[32:47], v[236:239], v[184:187], v[32:47]
    v_mfma_f32_32x32x16_bf16 v[48:63], v[232:235], v[188:191], v[48:63]
    v_mfma_f32_32x32x16_bf16 v[64:79], v[236:239], v[188:191], v[64:79]
    s_waitcnt vmcnt(2)
    v_mfma_f32_32x32x16_bf16 v[16:31], v[240:243], v[144:147], v[16:31]
    v_mfma_f32_32x32x16_bf16 v[32:47], v[244:247], v[144:147], v[32:47]
    v_mfma_f32_32x32x16_bf16 v[48:63], v[240:243], v[148:151], v[48:63]
    v_mfma_f32_32x32x16_bf16 v[64:79], v[244:247], v[148:151], v[64:79]
    s_waitcnt vmcnt(0)
    v_mfma_f32_32x32x16_bf16 v[16:31], v[248:251], v[192:195], v[16:31]
    v_mfma_f32_32x32x16_bf16 v[32:47], v[252:255], v[192:195], v[32:47]
    v_mfma_f32_32x32x16_bf16 v[48:63], v[248:251], v[196:199], v[48:63]
    v_mfma_f32_32x32x16_bf16 v[64:79], v[252:255], v[196:199], v[64:79]
    s_mov_b32 s73, 0
L_pl97:
    s_load_dwordx2 s[12:13], s[36:37], 256 glc
    s_load_dwordx2 s[14:15], s[36:37], 384 glc
    s_add_u32 s73, s73, 1
    s_cmp_ge_u32 s73, 65536
    s_waitcnt lgkmcnt(0)
    s_cbranch_scc1 L_pl98
    s_xor_b64 s[12:13], s[12:13], s[34:35]
    s_xor_b64 s[14:15], s[14:15], s[34:35]
    s_or_b64 s[12:13], s[12:13], s[14:15]
    s_cbranch_scc0 L_pl98
    s_sleep 1
    s_branch L_pl97
L_pl98:
    buffer_load_dwordx4 v[152:155], v6, s[20:23], s76 offen offset:0 sc1
    buffer_load_dwordx4 v[156:159], v5, s[20:23], s76 offen offset:0 sc1
    buffer_load_dwordx4 v[200:203], v6, s[20:23], s76 offen offset:1024 sc1
    buffer_load_dwordx4 v[204:207], v5, s[20:23], s76 offen offset:1024 sc1
    buffer_load_dwordx4 v[160:163], v6, s[20:23], s76 offen offset:2048 sc1
    buffer_load_dwordx4 v[164:167], v5, s[20:23], s76 offen offset:2048 sc1
    buffer_load_dwordx4 v[208:211], v6, s[20:23], s76 offen offset:3072 sc1
    buffer_load_dwordx4 v[212:215], v5, s[20:23], s76 offen offset:3072 sc1
    buffer_load_dwordx4 v[168:171], v6, s[20:23], s77 offen offset:0 sc1
    buffer_load_dwordx4 v[172:175], v5, s[20:23], s77 offen offset:0 sc1
    buffer_load_dwordx4 v[216:219], v6, s[20:23], s77 offen offset:1024 sc1
    buffer_load_dwordx4 v[220:223], v5, s[20:23], s77 offen offset:1024 sc1
    buffer_load_dwordx4 v[176:179], v6, s[20:23], s77 offen offset:2048 sc1
    buffer_load_dwordx4 v[180:183], v5, s[20:23], s77 offen offset:2048 sc1
    buffer_load_dwordx4 v[224:227], v6, s[20:23], s77 offen offset:3072 sc1
    buffer_load_dwordx4 v[228:231], v5, s[20:23], s77 offen offset:3072 sc1
    buffer_load_dwordx4 v[12:15], v7, s[4:7], s72 offen
    s_waitcnt vmcnt(15)
    v_mfma_f32_32x32x16_bf16 v[16:31], v[80:83], v[152:155], v[16:31]
    v_mfma_f32_32x32x16_bf16 v[32:47], v[84:87], v[152:155], v[32:47]
    v_mfma_f32_32x32x16_bf16 v[48:63], v[80:83], v[156:159], v[48:63]
    v_mfma_f32_32x32x16_bf16 v[64:79], v[84:87], v[156:159], v[64:79]
    s_waitcnt vmcnt(13)
    v_mfma_f32_32x32x16_bf16 v[16:31], v[88:91], v[200:203], v[16:31]
    v_mfma_f32_32x32x16_bf16 v[32:47], v[92:95], v[200:203], v[32:47]
    v_mfma_f32_32x32x16_bf16 v[48:63], v[88:91], v[204:207], v[48:63]
    v_mfma_f32_32x32x16_bf16 v[64:79], v[92:95], v[204:207], v[64:79]
    s_waitcnt vmcnt(11)
    v_mfma_f32_32x32x16_bf16 v[16:31], v[96:99], v[160:163], v[16:31]
    v_mfma_f32_32x32x16_bf16 v[32:47], v[100:103], v[160:163], v[32:47]
    v_mfma_f32_32x32x16_bf16 v[48:63], v[96:99], v[164:167], v[48:63]
    v_mfma_f32_32x32x16_bf16 v[64:79], v[100:103], v[164:167], v[64:79]
    s_waitcnt vmcnt(9)
    v_mfma_f32_32x32x16_bf16 v[16:31], v[104:107], v[208:211], v[16:31]
    v_mfma_f32_32x32x16_bf16 v[32:47], v[108:111], v[208:211], v[32:47]
    v_mfma_f32_32x32x16_bf16 v[48:63], v[104:107], v[212:215], v[48:63]
    v_mfma_f32_32x32x16_bf16 v[64:79], v[108:111], v[212:215], v[64:79]
    s_waitcnt vmcnt(7)
    v_mfma_f32_32x32x16_bf16 v[16:31], v[112:115], v[168:171], v[16:31]
    v_mfma_f32_32x32x16_bf16 v[32:47], v[116:119], v[168:171], v[32:47]
    v_mfma_f32_32x32x16_bf16 v[48:63], v[112:115], v[172:175], v[48:63]
    v_mfma_f32_32x32x16_bf16 v[64:79], v[116:119], v[172:175], v[64:79]
    s_waitcnt vmcnt(5)
    v_mfma_f32_32x32x16_bf16 v[16:31], v[120:123], v[216:219], v[16:31]
    v_mfma_f32_32x32x16_bf16 v[32:47], v[124:127], v[216:219], v[32:47]
    v_mfma_f32_32x32x16_bf16 v[48:63], v[120:123], v[220:223], v[48:63]
    v_mfma_f32_32x32x16_bf16 v[64:79], v[124:127], v[220:223], v[64:79]
    s_waitcnt vmcnt(3)
    v_mfma_f32_32x32x16_bf16 v[16:31], v[128:131], v[176:179], v[16:31]
    v_mfma_f32_32x32x16_bf16 v[32:47], v[132:135], v[176:179], v[32:47]
    v_mfma_f32_32x32x16_bf16 v[48:63], v[128:131], v[180:183], v[48:63]
    v_mfma_f32_32x32x16_bf16 v[64:79], v[132:135], v[180:183], v[64:79]
    s_waitcnt vmcnt(1)
    v_mfma_f32_32x32x16_bf16 v[16:31], v[136:139], v[224:227], v[16:31]
    v_mfma_f32_32x32x16_bf16 v[32:47], v[140:143], v[224:227], v[32:47]
    v_mfma_f32_32x32x16_bf16 v[48:63], v[136:139], v[228:231], v[48:63]
    v_mfma_f32_32x32x16_bf16 v[64:79], v[140:143], v[228:231], v[64:79]
    s_branch L_red
L_p2_dft:
    v_and_b32 v2, 31, v1
    v_lshrrev_b32 v3, 5, v1
    s_and_b32 s64, s2, 15
    s_lshl_b32 s64, s64, 7
    s_add_u32 s64, s64, 9568256
    s_add_u32 s36, s30, s64
    s_addc_u32 s37, s31, 0
    s_lshl_b32 s64, s69, 6
    s_cmp_ge_u32 s69, 4
    s_cbranch_scc1 L_direct
    s_sub_u32 s64, 256, s64
    v_sub_u32 v2, s64, v2
    v_lshlrev_b32 v6, 4, v2
    v_lshl_add_u32 v6, v3, 12, v6
    v_subrev_u32 v10, 512, v6
    s_sub_u32 s65, 16, s70
    s_and_b32 s65, s65, 15
    s_branch L_dft2
L_direct:
    s_sub_u32 s64, s64, 256
    v_add_u32 v2, s64, v2
    v_lshlrev_b32 v6, 4, v2
    v_lshl_add_u32 v6, v3, 12, v6
    v_add_u32 v10, 512, v6
    s_mov_b32 s65, s70
L_dft2:
    s_and_b32 s64, s68, 1
    s_lshl_b32 s64, s64, 9
    s_add_u32 s64, s64, s70
    v_and_b32 v8, 31, v1
    v_lshlrev_b32 v8, 4, v8
    v_add_u32 v8, s64, v8
    v_cvt_f32_u32 v8, v8
    s_mov_b32 s64, 0x3a000000
    s_cmp_ge_u32 s69, 4
    s_cselect_b32 s64, s64, 0xba000000
    v_mul_f32 v8, s64, v8
    v_lshrrev_b32 v9, 5, v1
    v_lshlrev_b32 v9, 3, v9
    v_cvt_f32_u32 v9, v9
    v_mul_f32 v9, v9, v8
    s_waitcnt vmcnt(4)
    v_fmamk_f32 v48, v8, 0x42000000, v9
    v_fmamk_f32 v49, v8, 0x42080000, v9
    v_fmamk_f32 v50, v8, 0x42100000, v9
    v_fmamk_f32 v51, v8, 0x42180000, v9
    v_cos_f32 v52, v48
    v_cos_f32 v53, v49
    v_cos_f32 v54, v50
    v_cos_f32 v55, v51
    v_sin_f32 v56, v48
    v_sin_f32 v57, v49
    v_sin_f32 v58, v50
    v_sin_f32 v59, v51
    v_cvt_pk_bf16_f32 v208, v52, v53
    v_cvt_pk_bf16_f32 v209, v54, v55
    v_cvt_pk_bf16_f32 v210, v56, v57
    v_cvt_pk_bf16_f32 v211, v58, v59
    v_fmamk_f32 v60, v8, 0x42040000, v9
    v_fmamk_f32 v61, v8, 0x420c0000, v9
    v_fmamk_f32 v62, v8, 0x42140000, v9
    v_fmamk_f32 v63, v8, 0x421c0000, v9
    v_cos_f32 v64, v60
    v_cos_f32 v65, v61
    v_cos_f32 v66, v62
    v_cos_f32 v67, v63
    v_sin_f32 v68, v60
    v_sin_f32 v69, v61
    v_sin_f32 v70, v62
    v_sin_f32 v71, v63
    v_cvt_pk_bf16_f32 v212, v64, v65
    v_cvt_pk_bf16_f32 v213, v66, v67
    v_cvt_pk_bf16_f32 v214, v68, v69
    v_cvt_pk_bf16_f32 v215, v70, v71
    v_fmamk_f32 v48, v8, 0x42400000, v9
    v_fmamk_f32 v49, v8, 0x42480000, v9
    v_fmamk_f32 v50, v8, 0x42500000, v9
    v_fmamk_f32 v51, v8, 0x42580000, v9
    v_cos_f32 v52, v48
    v_cos_f32 v53, v49
    v_cos_f32 v54, v50
    v_cos_f32 v55, v51
    v_sin_f32 v56, v48
    v_sin_f32 v57, v49
    v_sin_f32 v58, v50
    v_sin_f32 v59, v51
    v_cvt_pk_bf16_f32 v216, v52, v53
    v_cvt_pk_bf16_f32 v217, v54, v55
    v_cvt_pk_bf16_f32 v218, v56, v57
    v_cvt_pk_bf16_f32 v219, v58, v59
    v_fmamk_f32 v60, v8, 0x42440000, v9
    v_fmamk_f32 v61, v8, 0x424c0000, v9
    v_fmamk_f32 v62, v8, 0x42540000, v9
    v_fmamk_f32 v63, v8, 0x425c0000, v9
    v_cos_f32 v64, v60
    v_cos_f32 v65, v61
    v_cos_f32 v66, v62
    v_cos_f32 v67, v63
    v_sin_f32 v68, v60
    v_sin_f32 v69, v61
    v_sin_f32 v70, v62
    v_sin_f32 v71, v63
    v_cvt_pk_bf16_f32 v220, v64, v65
    v_cvt_pk_bf16_f32 v221, v66, v67
    v_cvt_pk_bf16_f32 v222, v68, v69
    v_cvt_pk_bf16_f32 v223, v70, v71
    v_fmamk_f32 v48, v8, 0x42800000, v9
    v_fmamk_f32 v49, v8, 0x42840000, v9
    v_fmamk_f32 v50, v8, 0x42880000, v9
    v_fmamk_f32 v51, v8, 0x428c0000, v9
    v_cos_f32 v52, v48
    v_cos_f32 v53, v49
    v_cos_f32 v54, v50
    v_cos_f32 v55, v51
    v_sin_f32 v56, v48
    v_sin_f32 v57, v49
    v_sin_f32 v58, v50
    v_sin_f32 v59, v51
    v_cvt_pk_bf16_f32 v224, v52, v53
    v_cvt_pk_bf16_f32 v225, v54, v55
    v_cvt_pk_bf16_f32 v226, v56, v57
    v_cvt_pk_bf16_f32 v227, v58, v59
    s_waitcnt vmcnt(0)
    v_mov_b32 v4, 147460
    v_mov_b32 v5, 1
    s_mov_b64 exec, 1
    ds_add_rtn_u32 v5, v4, v5
    s_waitcnt lgkmcnt(0)
    v_readfirstlane_b32 s73, v5
    s_mov_b64 exec, -1
    s_cmp_lg_u32 s73, s3
    s_cbranch_scc1 L_ar99
    s_cmp_eq_u32 s67, 1
    s_cbranch_scc1 L_az100
    s_atomic_swap_x2 s[34:35], s[30:31], s55
L_ar99:
    v_fmamk_f32 v60, v8, 0x42820000, v9
    v_fmamk_f32 v61, v8, 0x42860000, v9
    v_fmamk_f32 v62, v8, 0x428a0000, v9
    v_fmamk_f32 v63, v8, 0x428e0000, v9
    v_cos_f32 v64, v60
    v_cos_f32 v65, v61
    v_cos_f32 v66, v62
    v_cos_f32 v67, v63
    v_sin_f32 v68, v60
    v_sin_f32 v69, v61
    v_sin_f32 v70, v62
    v_sin_f32 v71, v63
    v_cvt_pk_bf16_f32 v228, v64, v65
    v_cvt_pk_bf16_f32 v229, v66, v67
    v_cvt_pk_bf16_f32 v230, v68, v69
    v_cvt_pk_bf16_f32 v231, v70, v71
    v_fmamk_f32 v48, v8, 0x42a00000, v9
    v_fmamk_f32 v49, v8, 0x42a40000, v9
    v_fmamk_f32 v50, v8, 0x42a80000, v9
    v_fmamk_f32 v51, v8, 0x42ac0000, v9
    v_cos_f32 v52, v48
    v_cos_f32 v53, v49
    v_cos_f32 v54, v50
    v_cos_f32 v55, v51
    v_sin_f32 v56, v48
    v_sin_f32 v57, v49
    v_sin_f32 v58, v50
    v_sin_f32 v59, v51
    v_cvt_pk_bf16_f32 v232, v52, v53
    v_cvt_pk_bf16_f32 v233, v54, v55
    v_cvt_pk_bf16_f32 v234, v56, v57
    v_cvt_pk_bf16_f32 v235, v58, v59
    v_fmamk_f32 v60, v8, 0x42a20000, v9
    v_fmamk_f32 v61, v8, 0x42a60000, v9
    v_fmamk_f32 v62, v8, 0x42aa0000, v9
    v_fmamk_f32 v63, v8, 0x42ae0000, v9
    v_cos_f32 v64, v60
    v_cos_f32 v65, v61
    v_cos_f32 v66, v62
    v_cos_f32 v67, v63
    v_sin_f32 v68, v60
    v_sin_f32 v69, v61
    v_sin_f32 v70, v62
    v_sin_f32 v71, v63
    v_cvt_pk_bf16_f32 v236, v64, v65
    v_cvt_pk_bf16_f32 v237, v66, v67
    v_cvt_pk_bf16_f32 v238, v68, v69
    v_cvt_pk_bf16_f32 v239, v70, v71
    v_fmamk_f32 v48, v8, 0x42c00000, v9
    v_fmamk_f32 v49, v8, 0x42c40000, v9
    v_fmamk_f32 v50, v8, 0x42c80000, v9
    v_fmamk_f32 v51, v8, 0x42cc0000, v9
    v_cos_f32 v52, v48
    v_cos_f32 v53, v49
    v_cos_f32 v54, v50
    v_cos_f32 v55, v51
    v_sin_f32 v56, v48
    v_sin_f32 v57, v49
    v_sin_f32 v58, v50
    v_sin_f32 v59, v51
    v_cvt_pk_bf16_f32 v240, v52, v53
    v_cvt_pk_bf16_f32 v241, v54, v55
    v_cvt_pk_bf16_f32 v242, v56, v57
    v_cvt_pk_bf16_f32 v243, v58, v59
    v_fmamk_f32 v60, v8, 0x42c20000, v9
    v_fmamk_f32 v61, v8, 0x42c60000, v9
    v_fmamk_f32 v62, v8, 0x42ca0000, v9
    v_fmamk_f32 v63, v8, 0x42ce0000, v9
    v_cos_f32 v64, v60
    v_cos_f32 v65, v61
    v_cos_f32 v66, v62
    v_cos_f32 v67, v63
    v_sin_f32 v68, v60
    v_sin_f32 v69, v61
    v_sin_f32 v70, v62
    v_sin_f32 v71, v63
    v_cvt_pk_bf16_f32 v244, v64, v65
    v_cvt_pk_bf16_f32 v245, v66, v67
    v_cvt_pk_bf16_f32 v246, v68, v69
    v_cvt_pk_bf16_f32 v247, v70, v71
    v_fmamk_f32 v48, v8, 0x42e00000, v9
    v_fmamk_f32 v49, v8, 0x42e40000, v9
    v_fmamk_f32 v50, v8, 0x42e80000, v9
    v_fmamk_f32 v51, v8, 0x42ec0000, v9
    v_cos_f32 v52, v48
    v_cos_f32 v53, v49
    v_cos_f32 v54, v50
    v_cos_f32 v55, v51
    v_sin_f32 v56, v48
    v_sin_f32 v57, v49
    v_sin_f32 v58, v50
    v_sin_f32 v59, v51
    v_cvt_pk_bf16_f32 v248, v52, v53
    v_cvt_pk_bf16_f32 v249, v54, v55
    v_cvt_pk_bf16_f32 v250, v56, v57
    v_cvt_pk_bf16_f32 v251, v58, v59
    v_fmamk_f32 v60, v8, 0x42e20000, v9
    v_fmamk_f32 v61, v8, 0x42e60000, v9
    v_fmamk_f32 v62, v8, 0x42ea0000, v9
    v_fmamk_f32 v63, v8, 0x42ee0000, v9
    v_cos_f32 v64, v60
    v_cos_f32 v65, v61
    v_cos_f32 v66, v62
    v_cos_f32 v67, v63
    v_sin_f32 v68, v60
    v_sin_f32 v69, v61
    v_sin_f32 v70, v62
    v_sin_f32 v71, v63
    v_cvt_pk_bf16_f32 v252, v64, v65
    v_cvt_pk_bf16_f32 v253, v66, v67
    v_cvt_pk_bf16_f32 v254, v68, v69
    v_cvt_pk_bf16_f32 v255, v70, v71
    s_cmp_eq_u32 s67, 0
    s_cbranch_scc1 L_havetw
    v_fmamk_f32 v48, v8, 0x00000000, v9
    v_fmamk_f32 v49, v8, 0x40000000, v9
    v_fmamk_f32 v50, v8, 0x40800000, v9
    v_fmamk_f32 v51, v8, 0x40c00000, v9
    v_cos_f32 v52, v48
    v_cos_f32 v53, v49
    v_cos_f32 v54, v50
    v_cos_f32 v55, v51
    v_sin_f32 v56, v48
    v_sin_f32 v57, v49
    v_sin_f32 v58, v50
    v_sin_f32 v59, v51
    v_cvt_pk_bf16_f32 v192, v52, v53
    v_cvt_pk_bf16_f32 v193, v54, v55
    v_cvt_pk_bf16_f32 v194, v56, v57
    v_cvt_pk_bf16_f32 v195, v58, v59
    v_fmamk_f32 v60, v8, 0x3f800000, v9
    v_fmamk_f32 v61, v8, 0x40400000, v9
    v_fmamk_f32 v62, v8, 0x40a00000, v9
    v_fmamk_f32 v63, v8, 0x40e00000, v9
    v_cos_f32 v64, v60
    v_cos_f32 v65, v61
    v_cos_f32 v66, v62
    v_cos_f32 v67, v63
    v_sin_f32 v68, v60
    v_sin_f32 v69, v61
    v_sin_f32 v70, v62
    v_sin_f32 v71, v63
    v_cvt_pk_bf16_f32 v196, v64, v65
    v_cvt_pk_bf16_f32 v197, v66, v67
    v_cvt_pk_bf16_f32 v198, v68, v69
    v_cvt_pk_bf16_f32 v199, v70, v71
    v_fmamk_f32 v48, v8, 0x41800000, v9
    v_fmamk_f32 v49, v8, 0x41900000, v9
    v_fmamk_f32 v50, v8, 0x41a00000, v9
    v_fmamk_f32 v51, v8, 0x41b00000, v9
    v_cos_f32 v52, v48
    v_cos_f32 v53, v49
    v_cos_f32 v54, v50
    v_cos_f32 v55, v51
    v_sin_f32 v56, v48
    v_sin_f32 v57, v49
    v_sin_f32 v58, v50
    v_sin_f32 v59, v51
    v_cvt_pk_bf16_f32 v200, v52, v53
    v_cvt_pk_bf16_f32 v201, v54, v55
    v_cvt_pk_bf16_f32 v202, v56, v57
    v_cvt_pk_bf16_f32 v203, v58, v59
    v_fmamk_f32 v60, v8, 0x41880000, v9
    v_fmamk_f32 v61, v8, 0x41980000, v9
    v_fmamk_f32 v62, v8, 0x41a80000, v9
    v_fmamk_f32 v63, v8, 0x41b80000, v9
    v_cos_f32 v64, v60
    v_cos_f32 v65, v61
    v_cos_f32 v66, v62
    v_cos_f32 v67, v63
    v_sin_f32 v68, v60
    v_sin_f32 v69, v61
    v_sin_f32 v70, v62
    v_sin_f32 v71, v63
    v_cvt_pk_bf16_f32 v204, v64, v65
    v_cvt_pk_bf16_f32 v205, v66, v67
    v_cvt_pk_bf16_f32 v206, v68, v69
    v_cvt_pk_bf16_f32 v207, v70, v71
L_havetw:
    s_lshl_b32 s64, s65, 17
    s_add_u32 s64, s64, 7340032
    s_mov_b32 s73, 0
L_pl101:
    s_load_dwordx2 s[12:13], s[36:37], 0 glc
    s_add_u32 s73, s73, 1
    s_cmp_ge_u32 s73, 65536
    s_waitcnt lgkmcnt(0)
    s_cbranch_scc1 L_pl102
    s_xor_b64 s[12:13], s[12:13], s[34:35]
    s_cbranch_scc0 L_pl102
    s_sleep 1
    s_branch L_pl101
L_pl102:
    s_setprio 1
    buffer_load_dwordx4 v[80:83], v6, s[20:23], s64 offen sc1
    buffer_load_dwordx4 v[84:87], v10, s[20:23], s64 offen sc1
    s_add_u32 s64, s64, 8192
    buffer_load_dwordx4 v[88:91], v6, s[20:23], s64 offen sc1
    buffer_load_dwordx4 v[92:95], v10, s[20:23], s64 offen sc1
    s_add_u32 s64, s64, 8192
    buffer_load_dwordx4 v[96:99], v6, s[20:23], s64 offen sc1
    buffer_load_dwordx4 v[100:103], v10, s[20:23], s64 offen sc1
    s_add_u32 s64, s64, 8192
    buffer_load_dwordx4 v[104:107], v6, s[20:23], s64 offen sc1
    buffer_load_dwordx4 v[108:111], v10, s[20:23], s64 offen sc1
    s_add_u32 s64, s64, 8192
    buffer_load_dwordx4 v[112:115], v6, s[20:23], s64 offen sc1
    buffer_load_dwordx4 v[116:119], v10, s[20:23], s64 offen sc1
    s_add_u32 s64, s64, 8192
    buffer_load_dwordx4 v[120:123], v6, s[20:23], s64 offen sc1
    buffer_load_dwordx4 v[124:127], v10, s[20:23], s64 offen sc1
    s_add_u32 s64, s64, 8192
    buffer_load_dwordx4 v[128:131], v6, s[20:23], s64 offen sc1
    buffer_load_dwordx4 v[132:135], v10, s[20:23], s64 offen sc1
    s_add_u32 s64, s64, 8192
    buffer_load_dwordx4 v[136:139], v6, s[20:23], s64 offen sc1
    buffer_load_dwordx4 v[140:143], v10, s[20:23], s64 offen sc1
    s_add_u32 s64, s64, 8192
    buffer_load_dwordx4 v[144:147], v6, s[20:23], s64 offen sc1
    buffer_load_dwordx4 v[148:151], v10, s[20:23], s64 offen sc1
    s_add_u32 s64, s64, 8192
    buffer_load_dwordx4 v[152:155], v6, s[20:23], s64 offen sc1
    buffer_load_dwordx4 v[156:159], v10, s[20:23], s64 offen sc1
    s_add_u32 s64, s64, 8192
    buffer_load_dwordx4 v[160:163], v6, s[20:23], s64 offen sc1
    buffer_load_dwordx4 v[164:167], v10, s[20:23], s64 offen sc1
    s_add_u32 s64, s64, 8192
    buffer_load_dwordx4 v[168:171], v6, s[20:23], s64 offen sc1
    buffer_load_dwordx4 v[172:175], v10, s[20:23], s64 offen sc1
    s_add_u32 s64, s64, 8192
    buffer_load_dwordx4 v[176:179], v6, s[20:23], s64 offen sc1
    buffer_load_dwordx4 v[180:183], v10, s[20:23], s64 offen sc1
    s_add_u32 s64, s64, 8192
    buffer_load_dwordx4 v[184:187], v6, s[20:23], s64 offen sc1
    buffer_load_dwordx4 v[188:191], v10, s[20:23], s64 offen sc1
    s_add_u32 s64, s64, 8192
    s_waitcnt vmcnt(26)
    v_mfma_f32_32x32x16_bf16 v[16:31], v[80:83], v[192:195], 0
    v_mfma_f32_32x32x16_bf16 v[32:47], v[84:87], v[192:195], 0
    buffer_load_dwordx4 v[80:83], v6, s[20:23], s64 offen sc1
    buffer_load_dwordx4 v[84:87], v10, s[20:23], s64 offen sc1
    s_add_u32 s64, s64, 8192
    s_waitcnt vmcnt(26)
    v_mfma_f32_32x32x16_bf16 v[48:63], v[88:91], v[196:199], 0
    v_mfma_f32_32x32x16_bf16 v[64:79], v[92:95], v[196:199], 0
    buffer_load_dwordx4 v[88:91], v6, s[20:23], s64 offen sc1
    buffer_load_dwordx4 v[92:95], v10, s[20:23], s64 offen sc1
    s_add_u32 s64, s64, 8192
    buffer_load_dwordx4 v[12:15], v7, s[4:7], s72 offen
    s_waitcnt vmcnt(27)
    v_mfma_f32_32x32x16_bf16 v[16:31], v[96:99], v[200:203], v[16:31]
    v_mfma_f32_32x32x16_bf16 v[32:47], v[100:103], v[200:203], v[32:47]
    s_waitcnt vmcnt(25)
    v_mfma_f32_32x32x16_bf16 v[48:63], v[104:107], v[204:207], v[48:63]
    v_mfma_f32_32x32x16_bf16 v[64:79], v[108:111], v[204:207], v[64:79]
    s_waitcnt vmcnt(23)
    v_mfma_f32_32x32x16_bf16 v[16:31], v[112:115], v[208:211], v[16:31]
    v_mfma_f32_32x32x16_bf16 v[32:47], v[116:119], v[208:211], v[32:47]
    s_waitcnt vmcnt(21)
    v_mfma_f32_32x32x16_bf16 v[48:63], v[120:123], v[212:215], v[48:63]
    v_mfma_f32_32x32x16_bf16 v[64:79], v[124:127], v[212:215], v[64:79]
    s_waitcnt vmcnt(19)
    v_mfma_f32_32x32x16_bf16 v[16:31], v[128:131], v[216:219], v[16:31]
    v_mfma_f32_32x32x16_bf16 v[32:47], v[132:135], v[216:219], v[32:47]
    s_waitcnt vmcnt(17)
    v_mfma_f32_32x32x16_bf16 v[48:63], v[136:139], v[220:223], v[48:63]
    v_mfma_f32_32x32x16_bf16 v[64:79], v[140:143], v[220:223], v[64:79]
    s_waitcnt vmcnt(15)
    v_mfma_f32_32x32x16_bf16 v[16:31], v[144:147], v[224:227], v[16:31]
    v_mfma_f32_32x32x16_bf16 v[32:47], v[148:151], v[224:227], v[32:47]
    s_waitcnt vmcnt(13)
    v_mfma_f32_32x32x16_bf16 v[48:63], v[152:155], v[228:231], v[48:63]
    v_mfma_f32_32x32x16_bf16 v[64:79], v[156:159], v[228:231], v[64:79]
    s_waitcnt vmcnt(11)
    v_mfma_f32_32x32x16_bf16 v[16:31], v[160:163], v[232:235], v[16:31]
    v_mfma_f32_32x32x16_bf16 v[32:47], v[164:167], v[232:235], v[32:47]
    s_waitcnt vmcnt(9)
    v_mfma_f32_32x32x16_bf16 v[48:63], v[168:171], v[236:239], v[48:63]
    v_mfma_f32_32x32x16_bf16 v[64:79], v[172:175], v[236:239], v[64:79]
    s_waitcnt vmcnt(7)
    v_mfma_f32_32x32x16_bf16 v[16:31], v[176:179], v[240:243], v[16:31]
    v_mfma_f32_32x32x16_bf16 v[32:47], v[180:183], v[240:243], v[32:47]
    s_waitcnt vmcnt(5)
    v_mfma_f32_32x32x16_bf16 v[48:63], v[184:187], v[244:247], v[48:63]
    v_mfma_f32_32x32x16_bf16 v[64:79], v[188:191], v[244:247], v[64:79]
    s_waitcnt vmcnt(3)
    v_mfma_f32_32x32x16_bf16 v[16:31], v[80:83], v[248:251], v[16:31]
    v_mfma_f32_32x32x16_bf16 v[32:47], v[84:87], v[248:251], v[32:47]
    s_waitcnt vmcnt(1)
    v_mfma_f32_32x32x16_bf16 v[48:63], v[88:91], v[252:255], v[48:63]
    v_mfma_f32_32x32x16_bf16 v[64:79], v[92:95], v[252:255], v[64:79]
    s_nop 11
    v_sub_f32 v48, v16, v48
    v_sub_f32 v49, v17, v49
    v_sub_f32 v50, v18, v50
    v_sub_f32 v51, v19, v51
    v_sub_f32 v52, v20, v52
    v_sub_f32 v53, v21, v53
    v_sub_f32 v54, v22, v54
    v_sub_f32 v55, v23, v55
    v_sub_f32 v56, v24, v56
    v_sub_f32 v57, v25, v57
    v_sub_f32 v58, v26, v58
    v_sub_f32 v59, v27, v59
    v_sub_f32 v60, v28, v60
    v_sub_f32 v61, v29, v61
    v_sub_f32 v62, v30, v62
    v_sub_f32 v63, v31, v63
    v_sub_f32 v64, v32, v64
    v_sub_f32 v65, v33, v65
    v_sub_f32 v66, v34, v66
    v_sub_f32 v67, v35, v67
    v_sub_f32 v68, v36, v68
    v_sub_f32 v69, v37, v69
    v_sub_f32 v70, v38, v70
    v_sub_f32 v71, v39, v71
    v_sub_f32 v72, v40, v72
    v_sub_f32 v73, v41, v73
    v_sub_f32 v74, v42, v74
    v_sub_f32 v75, v43, v75
    v_sub_f32 v76, v44, v76
    v_sub_f32 v77, v45, v77
    v_sub_f32 v78, v46, v78
    v_sub_f32 v79, v47, v79
    v_fma_f32 v16, v16, 2.0, -v48
    v_fma_f32 v17, v17, 2.0, -v49
    v_fma_f32 v18, v18, 2.0, -v50
    v_fma_f32 v19, v19, 2.0, -v51
    v_fma_f32 v20, v20, 2.0, -v52
    v_fma_f32 v21, v21, 2.0, -v53
    v_fma_f32 v22, v22, 2.0, -v54
    v_fma_f32 v23, v23, 2.0, -v55
    v_fma_f32 v24, v24, 2.0, -v56
    v_fma_f32 v25, v25, 2.0, -v57
    v_fma_f32 v26, v26, 2.0, -v58
    v_fma_f32 v27, v27, 2.0, -v59
    v_fma_f32 v28, v28, 2.0, -v60
    v_fma_f32 v29, v29, 2.0, -v61
    v_fma_f32 v30, v30, 2.0, -v62
    v_fma_f32 v31, v31, 2.0, -v63
    v_fma_f32 v32, v32, 2.0, -v64
    v_fma_f32 v33, v33, 2.0, -v65
    v_fma_f32 v34, v34, 2.0, -v66
    v_fma_f32 v35, v35, 2.0, -v67
    v_fma_f32 v36, v36, 2.0, -v68
    v_fma_f32 v37, v37, 2.0, -v69
    v_fma_f32 v38, v38, 2.0, -v70
    v_fma_f32 v39, v39, 2.0, -v71
    v_fma_f32 v40, v40, 2.0, -v72
    v_fma_f32 v41, v41, 2.0, -v73
    v_fma_f32 v42, v42, 2.0, -v74
    v_fma_f32 v43, v43, 2.0, -v75
    v_fma_f32 v44, v44, 2.0, -v76
    v_fma_f32 v45, v45, 2.0, -v77
    v_fma_f32 v46, v46, 2.0, -v78
    v_fma_f32 v47, v47, 2.0, -v79
L_red:
    v_bfe_u32 v2, v1, 2, 3
    v_lshlrev_b32 v2, 13, v2
    v_and_b32 v3, 3, v1
    v_lshl_add_u32 v2, v3, 8, v2
    v_lshrrev_b32 v3, 5, v1
    v_and_b32 v4, 7, v1
    v_xor_b32 v3, v3, v4
    v_lshl_add_u32 v2, v3, 4, v2
    s_lshl_b32 s64, s50, 10
    v_add_u32 v80, s64, v2
    v_xor_b32 v81, 32, v80
    v_xor_b32 v82, 64, v80
    v_xor_b32 v83, 96, v80
    v_add_u32 v84, 65536, v80
    v_add_u32 v85, 65536, v81
    v_add_u32 v86, 65536, v82
    v_add_u32 v87, 65536, v83
    ds_write_b128 v80, v[16:19] offset:0
    ds_write_b128 v81, v[20:23] offset:0
    ds_write_b128 v82, v[24:27] offset:0
    ds_write_b128 v83, v[28:31] offset:0
    ds_write_b128 v80, v[32:35] offset:128
    ds_write_b128 v81, v[36:39] offset:128
    ds_write_b128 v82, v[40:43] offset:128
    ds_write_b128 v83, v[44:47] offset:128
    ds_write_b128 v84, v[48:51] offset:0
    ds_write_b128 v85, v[52:55] offset:0
    ds_write_b128 v86, v[56:59] offset:0
    ds_write_b128 v87, v[60:63] offset:0
    ds_write_b128 v84, v[64:67] offset:128
    ds_write_b128 v85, v[68:71] offset:128
    ds_write_b128 v86, v[72:75] offset:128
    ds_write_b128 v87, v[76:79] offset:128
    v_lshrrev_b32 v2, 3, v0
    v_and_b32 v3, 7, v0
    v_lshlrev_b32 v9, 1, v3
    v_and_b32 v10, 7, v2
    v_xor_b32 v9, v9, v10
    v_lshlrev_b32 v9, 4, v9
    v_and_b32 v10, 3, v2
    v_lshl_add_u32 v9, v10, 8, v9
    v_lshrrev_b32 v10, 2, v2
    v_lshl_add_u32 v9, v10, 13, v9
    v_xor_b32 v10, 16, v9
    v_or_b32 v3, s69, v3
    v_cmp_ne_u32 vcc, 0, v3
    s_mov_b32 s74, 0xbfb8aa3b
    s_waitcnt lgkmcnt(0)
    s_barrier
    ds_read_b128 v[128:131], v9 offset:0
    ds_read_b128 v[132:135], v10 offset:0
    ds_read_b128 v[136:139], v9 offset:1024
    ds_read_b128 v[140:143], v10 offset:1024
    ds_read_b128 v[144:147], v9 offset:2048
    ds_read_b128 v[148:151], v10 offset:2048
    ds_read_b128 v[152:155], v9 offset:3072
    ds_read_b128 v[156:159], v10 offset:3072
    ds_read_b128 v[160:163], v9 offset:4096
    ds_read_b128 v[164:167], v10 offset:4096
    ds_read_b128 v[168:171], v9 offset:5120
    ds_read_b128 v[172:175], v10 offset:5120
    ds_read_b128 v[176:179], v9 offset:6144
    ds_read_b128 v[180:183], v10 offset:6144
    ds_read_b128 v[184:187], v9 offset:7168
    ds_read_b128 v[188:191], v10 offset:7168
    s_waitcnt lgkmcnt(12)
    v_pk_add_f32 v[128:129], v[128:129], v[136:137]
    v_pk_add_f32 v[130:131], v[130:131], v[138:139]
    v_pk_add_f32 v[132:133], v[132:133], v[140:141]
    v_pk_add_f32 v[134:135], v[134:135], v[142:143]
    s_waitcnt lgkmcnt(8)
    v_pk_add_f32 v[144:145], v[144:145], v[152:153]
    v_pk_add_f32 v[146:147], v[146:147], v[154:155]
    v_pk_add_f32 v[148:149], v[148:149], v[156:157]
    v_pk_add_f32 v[150:151], v[150:151], v[158:159]
    s_waitcnt lgkmcnt(4)
    v_pk_add_f32 v[160:161], v[160:161], v[168:169]
    v_pk_add_f32 v[162:163], v[162:163], v[170:171]
    v_pk_add_f32 v[164:165], v[164:165], v[172:173]
    v_pk_add_f32 v[166:167], v[166:167], v[174:175]
    v_pk_add_f32 v[128:129], v[128:129], v[144:145]
    v_pk_add_f32 v[130:131], v[130:131], v[146:147]
    v_pk_add_f32 v[132:133], v[132:133], v[148:149]
    v_pk_add_f32 v[134:135], v[134:135], v[150:151]
    s_waitcnt lgkmcnt(2)
    v_pk_add_f32 v[160:161], v[160:161], v[176:177]
    v_pk_add_f32 v[162:163], v[162:163], v[178:179]
    v_pk_add_f32 v[164:165], v[164:165], v[180:181]
    v_pk_add_f32 v[166:167], v[166:167], v[182:183]
    v_pk_add_f32 v[128:129], v[128:129], v[160:161]
    v_pk_add_f32 v[130:131], v[130:131], v[162:163]
    v_pk_add_f32 v[132:133], v[132:133], v[164:165]
    v_pk_add_f32 v[134:135], v[134:135], v[166:167]
    v_pk_mul_f32 v[16:17], v[128:129], s[74:75] op_sel_hi:[1,0]
    v_pk_mul_f32 v[18:19], v[130:131], s[74:75] op_sel_hi:[1,0]
    v_pk_mul_f32 v[20:21], v[132:133], s[74:75] op_sel_hi:[1,0]
    v_pk_mul_f32 v[22:23], v[134:135], s[74:75] op_sel_hi:[1,0]
    v_exp_f32 v16, v16
    v_exp_f32 v17, v17
    v_exp_f32 v18, v18
    v_exp_f32 v19, v19
    v_exp_f32 v20, v20
    v_exp_f32 v21, v21
    v_exp_f32 v22, v22
    v_exp_f32 v23, v23
    s_nop 0
    v_pk_add_f32 v[16:17], v[16:17], 1.0 op_sel_hi:[1,0]
    v_pk_add_f32 v[18:19], v[18:19], 1.0 op_sel_hi:[1,0]
    v_pk_add_f32 v[20:21], v[20:21], 1.0 op_sel_hi:[1,0]
    v_pk_add_f32 v[22:23], v[22:23], 1.0 op_sel_hi:[1,0]
    v_rcp_f32 v16, v16
    v_rcp_f32 v17, v17
    v_rcp_f32 v18, v18
    v_rcp_f32 v19, v19
    v_rcp_f32 v20, v20
    v_rcp_f32 v21, v21
    v_rcp_f32 v22, v22
    v_rcp_f32 v23, v23
    s_waitcnt vmcnt(0) lgkmcnt(0)
    v_cndmask_b32 v184, 0, v184, vcc
    v_lshlrev_b32 v24, 16, v12
    v_and_b32 v25, s66, v12
    v_lshlrev_b32 v26, 16, v13
    v_and_b32 v27, s66, v13
    v_lshlrev_b32 v28, 16, v14
    v_and_b32 v29, s66, v14
    v_lshlrev_b32 v30, 16, v15
    v_and_b32 v31, s66, v15
    v_pk_mul_f32 v[16:17], v[16:17], v[128:129]
    v_pk_mul_f32 v[18:19], v[18:19], v[130:131]
    v_pk_mul_f32 v[20:21], v[20:21], v[132:133]
    v_pk_mul_f32 v[22:23], v[22:23], v[134:135]
    v_pk_fma_f32 v[16:17], v[16:17], v[184:185], v[24:25]
    v_pk_fma_f32 v[18:19], v[18:19], v[186:187], v[26:27]
    v_pk_fma_f32 v[20:21], v[20:21], v[188:189], v[28:29]
    v_pk_fma_f32 v[22:23], v[22:23], v[190:191], v[30:31]
    v_cvt_pk_bf16_f32 v12, v16, v17
    v_cvt_pk_bf16_f32 v13, v18, v19
    v_cvt_pk_bf16_f32 v14, v20, v21
    v_cvt_pk_bf16_f32 v15, v22, v23
    buffer_store_dwordx4 v[12:15], v7, s[8:11], s72 offen
L_end:
    s_endpgm
L_ns7:
    s_mov_b32 s73, 0
L_ns8:
    global_load_dwordx2 v[14:15], v166, s[24:25] sc1
    s_add_u32 s73, s73, 1
    s_waitcnt vmcnt(0)
    v_readfirstlane_b32 s61, v14
    s_cmp_ge_u32 s73, 65536
    s_cbranch_scc1 L_nb6
    s_cmp_eq_u32 s61, 0
    s_cbranch_scc1 L_ns8
    s_branch L_nb6
L_ts14:
    s_mov_b32 s73, 0
L_ts15:
    s_sleep 2
    buffer_load_dwordx2 v[146:147], v171, s[20:23], 0 offen sc1
    s_add_u32 s73, s73, 1
    s_waitcnt vmcnt(0)
    v_cmp_ne_u32 s[78:79], v147, v14
    s_cmp_ge_u32 s73, 65536
    s_cbranch_scc1 L_tb13
    s_cmp_lg_u64 s[78:79], 0
    s_cbranch_scc1 L_ts15
    s_branch L_tb13
L_ts17:
    s_mov_b32 s73, 0
L_ts18:
    s_sleep 2
    buffer_load_dwordx2 v[190:191], v174, s[20:23], 0 offen sc1
    s_add_u32 s73, s73, 1
    s_waitcnt vmcnt(0)
    v_cmp_ne_u64 s[78:79], v[190:191], v[14:15]
    s_cmp_ge_u32 s73, 65536
    s_cbranch_scc1 L_tb16
    s_cmp_lg_u64 s[78:79], 0
    s_cbranch_scc1 L_ts18
    s_branch L_tb16
L_ns25:
    s_mov_b32 s73, 0
L_ns26:
    global_load_dwordx2 v[14:15], v166, s[24:25] sc1
    s_add_u32 s73, s73, 1
    s_waitcnt vmcnt(0)
    v_readfirstlane_b32 s61, v14
    s_cmp_ge_u32 s73, 65536
    s_cbranch_scc1 L_nb24
    s_cmp_eq_u32 s61, 0
    s_cbranch_scc1 L_ns26
    s_branch L_nb24
L_ts29:
    s_mov_b32 s73, 0
L_ts30:
    s_sleep 2
    buffer_load_dwordx2 v[146:147], v171, s[20:23], 0 offen sc1
    s_add_u32 s73, s73, 1
    s_waitcnt vmcnt(0)
    v_cmp_ne_u32 s[78:79], v147, v14
    s_cmp_ge_u32 s73, 65536
    s_cbranch_scc1 L_tb28
    s_cmp_lg_u64 s[78:79], 0
    s_cbranch_scc1 L_ts30
    s_branch L_tb28
L_ts32:
    s_mov_b32 s73, 0
L_ts33:
    s_sleep 2
    buffer_load_dwordx2 v[190:191], v174, s[20:23], 0 offen sc1
    s_add_u32 s73, s73, 1
    s_waitcnt vmcnt(0)
    v_cmp_ne_u64 s[78:79], v[190:191], v[14:15]
    s_cmp_ge_u32 s73, 65536
    s_cbranch_scc1 L_tb31
    s_cmp_lg_u64 s[78:79], 0
    s_cbranch_scc1 L_ts33
    s_branch L_tb31
L_ns54:
    s_mov_b32 s73, 0
L_ns55:
    global_load_dwordx2 v[14:15], v166, s[24:25] sc1
    s_add_u32 s73, s73, 1
    s_waitcnt vmcnt(0)
    v_readfirstlane_b32 s61, v14
    s_cmp_ge_u32 s73, 65536
    s_cbranch_scc1 L_nb53
    s_cmp_eq_u32 s61, 0
    s_cbranch_scc1 L_ns55
    s_branch L_nb53
L_ts82:
    s_mov_b32 s73, 0
L_ts83:
    s_sleep 2
    buffer_load_dwordx2 v[146:147], v171, s[20:23], 0 offen sc1
    s_add_u32 s73, s73, 1
    s_waitcnt vmcnt(0)
    v_cmp_ne_u32 s[78:79], v147, v14
    s_cmp_ge_u32 s73, 65536
    s_cbranch_scc1 L_tb81
    s_cmp_lg_u64 s[78:79], 0
    s_cbranch_scc1 L_ts83
    s_branch L_tb81
L_ts89:
    s_mov_b32 s73, 0
L_ts90:
    s_sleep 2
    buffer_load_dwordx2 v[190:191], v174, s[20:23], 0 offen sc1
    s_add_u32 s73, s73, 1
    s_waitcnt vmcnt(0)
    v_cmp_ne_u64 s[78:79], v[190:191], v[14:15]
    s_cmp_ge_u32 s73, 65536
    s_cbranch_scc1 L_tb88
    s_cmp_lg_u64 s[78:79], 0
    s_cbranch_scc1 L_ts90
    s_branch L_tb88
L_az92:
    s_mov_b32 s73, 1
    s_atomic_add s73, s[24:25], 128 glc
    s_add_u32 s78, s30, 9568256
    s_addc_u32 s79, s31, 0
    s_waitcnt lgkmcnt(0)
    s_cmp_lg_u32 s73, 31
    s_cbranch_scc1 L_ar91
    s_atomic_swap_x2 s[34:35], s[78:79], 0
    s_atomic_swap_x2 s[34:35], s[78:79], 128
    s_atomic_swap_x2 s[34:35], s[78:79], 256
    s_atomic_swap_x2 s[34:35], s[78:79], 384
    s_atomic_swap_x2 s[34:35], s[78:79], 512
    s_atomic_swap_x2 s[34:35], s[78:79], 640
    s_atomic_swap_x2 s[34:35], s[78:79], 768
    s_atomic_swap_x2 s[34:35], s[78:79], 896
    s_atomic_swap_x2 s[34:35], s[78:79], 1024
    s_atomic_swap_x2 s[34:35], s[78:79], 1152
    s_atomic_swap_x2 s[34:35], s[78:79], 1280
    s_atomic_swap_x2 s[34:35], s[78:79], 1408
    s_atomic_swap_x2 s[34:35], s[78:79], 1536
    s_atomic_swap_x2 s[34:35], s[78:79], 1664
    s_atomic_swap_x2 s[34:35], s[78:79], 1792
    s_atomic_swap_x2 s[34:35], s[78:79], 1920
    s_branch L_ar91
L_az100:
    s_mov_b32 s73, 1
    s_atomic_add s73, s[24:25], 128 glc
    s_add_u32 s78, s30, 9568256
    s_addc_u32 s79, s31, 0
    s_waitcnt lgkmcnt(0)
    s_cmp_lg_u32 s73, 31
    s_cbranch_scc1 L_ar99
    s_atomic_swap_x2 s[34:35], s[78:79], 0
    s_atomic_swap_x2 s[34:35], s[78:79], 128
    s_atomic_swap_x2 s[34:35], s[78:79], 256
    s_atomic_swap_x2 s[34:35], s[78:79], 384
    s_atomic_swap_x2 s[34:35], s[78:79], 512
    s_atomic_swap_x2 s[34:35], s[78:79], 640
    s_atomic_swap_x2 s[34:35], s[78:79], 768
    s_atomic_swap_x2 s[34:35], s[78:79], 896
    s_atomic_swap_x2 s[34:35], s[78:79], 1024
    s_atomic_swap_x2 s[34:35], s[78:79], 1152
    s_atomic_swap_x2 s[34:35], s[78:79], 1280
    s_atomic_swap_x2 s[34:35], s[78:79], 1408
    s_atomic_swap_x2 s[34:35], s[78:79], 1536
    s_atomic_swap_x2 s[34:35], s[78:79], 1664
    s_atomic_swap_x2 s[34:35], s[78:79], 1792
    s_atomic_swap_x2 s[34:35], s[78:79], 1920
    s_branch L_ar99
.section .rodata,"a"
.p2align 6
.amdhsa_kernel recurrent_scan__spectral_fnet__geglu_ffn__prompt_kernel
.amdhsa_next_free_vgpr 256
.amdhsa_next_free_sgpr 102
.amdhsa_accum_offset 256
.amdhsa_group_segment_fixed_size 0
.amdhsa_kernarg_size 96
.amdhsa_user_sgpr_count 2
.amdhsa_user_sgpr_kernarg_segment_ptr 1
.amdhsa_system_sgpr_workgroup_id_x 1
.end_amdhsa_kernel
```
